```python
import torch

def _softmax(x, axis=-1):
    return torch.softmax(x, dim=axis)
def _gelu(x):
    return torch.nn.functional.gelu(x, approximate="tanh")
def _silu(x):
    return torch.nn.functional.silu(x)
def _sigmoid(x):
    return torch.sigmoid(x)
def _layernorm(x, axis=-1, eps=1e-5):
    m = x.mean(dim=axis, keepdim=True)
    v = x.var(dim=axis, keepdim=True, unbiased=False)
    return (x - m) / torch.sqrt(v + eps)
def _scatter_add(tgt, idx, src, axis=0):
    return tgt.clone().index_add_(axis, idx, src)
def _segment_sum(src, seg, n):
    out = torch.zeros((n,) + src.shape[1:], dtype=src.dtype)
    return out.index_add_(0, seg, src)
def _pad(x, pw):
    flat = tuple(v for pair in reversed(pw) for v in pair)
    return torch.nn.functional.pad(x, flat)

kernel_name = 'gated_mix__ssm_conv_s4d__grouped_kv_mqa__prompt'

def setup_inputs():

    _w = (lambda a: (lambda t: t.to(torch.bfloat16) if t.is_floating_point() else t)(torch.as_tensor(a)))
    def _A_setup():
        Bsz, L, D, N = 1, 2048, 576, 128
        return {
            "u": _w((lambda *s: torch.randn(*s, dtype=torch.bfloat16) * 0.05)(Bsz, L, D)),
            "log_A_real": _w((lambda *s: torch.randn(*s, dtype=torch.bfloat16) * 6.4)(D, N) * 0.5),
            "A_imag": _w((lambda *s: torch.randn(*s, dtype=torch.bfloat16) * 0.05)(D, N) * 3.14),
            "C_real": _w((lambda *s: torch.randn(*s, dtype=torch.bfloat16) * 0.05)(D, N) / N ** 0.5),
            "C_imag": _w((lambda *s: torch.randn(*s, dtype=torch.bfloat16) * 0.05)(D, N) / N ** 0.5),
            "log_dt": _w((lambda *s: torch.randn(*s, dtype=torch.bfloat16) * 0.05)(D) * 0.5 - 4.0),
            "D_skip": _w((lambda *s: torch.randn(*s, dtype=torch.bfloat16) * 0.05)(D)),
        }
    _A_in = _A_setup()

    def _B_setup():
        B, S, D, H = 1, 2048, 576, 32
        Dh = D // H
        return {
            "x": _w((lambda *s: torch.randn(*s, dtype=torch.bfloat16) * 0.05)(B, S, D)),
            "wq": _w((lambda *s: torch.randn(*s, dtype=torch.bfloat16) * 0.8)(D, H * Dh)),
            "wk": _w((lambda *s: torch.randn(*s, dtype=torch.bfloat16) * 0.8)(D, Dh)),
            "wv": _w((lambda *s: torch.randn(*s, dtype=torch.bfloat16) * 0.05)(D, Dh)),
            "wo": _w((lambda *s: torch.randn(*s, dtype=torch.bfloat16) * 0.05)(H * Dh, D)),
        }
    _B_in = _B_setup()

    return {
        "A_u": _A_in["u"],
        "A_log_A_real": _A_in["log_A_real"],
        "A_A_imag": _A_in["A_imag"],
        "A_C_real": _A_in["C_real"],
        "A_C_imag": _A_in["C_imag"],
        "A_log_dt": _A_in["log_dt"],
        "A_D_skip": _A_in["D_skip"],
        "B_x": _B_in["x"],
        "B_wq": _B_in["wq"],
        "B_wk": _B_in["wk"],
        "B_wv": _B_in["wv"],
        "B_wo": _B_in["wo"],
        "gate_w": _w((lambda *s: torch.randn(*s, dtype=torch.bfloat16) * 0.05)(576) * 16.0),
    }

def reference(A_u, A_log_A_real, A_A_imag, A_C_real, A_C_imag, A_log_dt, A_D_skip, B_x, B_wq, B_wk, B_wv, B_wo, gate_w):
    def _A_ref(u, log_A_real, A_imag, C_real, C_imag, log_dt, D_skip):
        L = u.shape[1]
        dt = torch.exp(log_dt)
        A = -torch.exp(log_A_real) + 1j * A_imag
        C = (C_real + 1j * C_imag) * dt[:, None]
        pos = (lambda x, dt: x.to(dt))(torch.arange(L), log_dt.dtype)
        P = torch.exp((A * dt[:, None])[:, :, None] * pos[None, None, :])
        K = 2.0 * torch.einsum("dn,dnl->dl", C, P).real
        L2 = 2 * L
        u_t = (lambda x, *d: x.permute(*d))(u, 0, 2, 1)
        Kf = (lambda x, *a, **k: torch.fft.rfft(x.float(), *a, **k))(K, L2)
        Uf = (lambda x, *a, **k: torch.fft.rfft(x.float(), *a, **k))(u_t, L2)
        y = (lambda x, *a, **k: torch.fft.irfft(x, *a, **k).to(torch.bfloat16))(Uf * Kf[None, :, :], L2)[:, :, :L]
        y = (lambda x, *d: x.permute(*d))(y, 0, 2, 1)
        return y + u * D_skip[None, None, :]

    def _B_ref(x, wq, wk, wv, wo):
        B, S, D = x.shape
        H = 32
        Dh = D // H
        q = (lambda x, *d: x.permute(*d))((x @ wq).reshape(B, S, H, Dh), 0, 2, 1, 3)
        k = x @ wk
        v = x @ wv
        scores = torch.einsum("bhqd,bkd->bhqk", q, k) * (Dh ** -0.5)
        p = _softmax(scores, axis=-1)
        o = torch.einsum("bhqk,bkd->bhqd", p, v)
        return (lambda x, *d: x.permute(*d))(o, 0, 2, 1, 3).reshape(B, S, H * Dh) @ wo

    x = A_u
    g = _sigmoid((x * gate_w).sum(-1, keepdims=True))
    a = _A_ref(x, A_log_A_real, A_A_imag, A_C_real, A_C_imag, A_log_dt, A_D_skip)
    b = _B_ref(x, B_wq, B_wk, B_wv, B_wo)
    return g * a + (1 - g) * b
```

```asm
; @launch kernel=prep_kernel grid=(512,1,1) block=(256,1,1) lds=67584
; @launch kernel=attn_kernel grid=(256,1,1) block=(704,1,1) lds=153168
; @launch kernel=outp_kernel grid=(192,1,1) block=(256,1,1) lds=67584
.amdgcn_target "amdgcn-amd-amdhsa--gfx950"
.text
.globl prep_kernel
.p2align 8
.type prep_kernel,@function
prep_kernel:
    s_movk_i32 s90, 0x7fff
    s_load_dwordx2 s[4:5], s[0:1], 0
    s_load_dwordx2 s[6:7], s[0:1], 120
    s_cmp_lt_u32 s2, 288
    s_cbranch_scc1 K1_KGEN
    s_cmp_lt_u32 s2, 480
    s_cbranch_scc1 K1_QP
    s_cmp_lt_u32 s2, 512
    s_cbranch_scc1 K1_KV
    s_endpgm
K1_QP:
    s_load_dwordx2 s[8:9], s[0:1], 64
    s_sub_u32 s24, s2, 288
    s_and_b32 s15, s24, 7
    s_lshr_b32 s3, s24, 3
    s_mov_b32 s14, 357913942
    s_mul_hi_u32 s12, s3, s14
    s_mul_i32 s14, s12, 12
    s_sub_u32 s13, s3, s14
    s_lshl_b32 s12, s12, 3
    s_add_u32 s12, s12, s15
    s_lshl_b32 s12, s12, 7
    s_mul_i32 s13, s13, 48
    v_and_b32 v1, 63, v0
    v_lshrrev_b32 v4, 6, v0
    v_lshrrev_b32 v2, 4, v1
    v_and_b32 v3, 15, v1
    s_movk_i32 s91, 1152
    v_readfirstlane_b32 s89, v4
    v_lshl_add_u32 v5, v4, 5, v3
    v_add_u32 v5, s12, v5
    v_mul_lo_u32 v5, v5, s91
    v_lshl_add_u32 v5, v2, 4, v5
    v_add_u32 v7, 18432, v5
    s_mov_b32 s86, 55296
    s_waitcnt lgkmcnt(0)
    s_lshl_b32 s92, s13, 1
    s_lshl_b32 s88, s89, 10
    s_mov_b32 s87, 715827883
    v_add_u32 v9, 0, v0
    v_mul_hi_u32 v10, v9, s87
    v_mul_u32_u24 v11, 6, v10
    v_sub_u32 v11, v9, v11
    v_mul_lo_u32 v6, v10, s91
    v_lshl_add_u32 v6, v11, 4, v6
    v_add_u32 v6, s92, v6
    s_add_u32 m0, s88, 0
    s_nop 0
    global_load_lds_dwordx4 v6, s[8:9]
    v_add_u32 v9, 256, v0
    v_mul_hi_u32 v10, v9, s87
    v_mul_u32_u24 v11, 6, v10
    v_sub_u32 v11, v9, v11
    v_mul_lo_u32 v6, v10, s91
    v_lshl_add_u32 v6, v11, 4, v6
    v_add_u32 v6, s92, v6
    s_add_u32 m0, s88, 4096
    s_nop 0
    global_load_lds_dwordx4 v6, s[8:9]
    v_add_u32 v9, 512, v0
    v_mul_hi_u32 v10, v9, s87
    v_mul_u32_u24 v11, 6, v10
    v_sub_u32 v11, v9, v11
    v_mul_lo_u32 v6, v10, s91
    v_lshl_add_u32 v6, v11, 4, v6
    v_add_u32 v6, s92, v6
    s_add_u32 m0, s88, 8192
    s_nop 0
    global_load_lds_dwordx4 v6, s[8:9]
    v_add_u32 v9, 768, v0
    v_mul_hi_u32 v10, v9, s87
    v_mul_u32_u24 v11, 6, v10
    v_sub_u32 v11, v9, v11
    v_mul_lo_u32 v6, v10, s91
    v_lshl_add_u32 v6, v11, 4, v6
    v_add_u32 v6, s92, v6
    s_add_u32 m0, s88, 12288
    s_nop 0
    global_load_lds_dwordx4 v6, s[8:9]
    v_add_u32 v9, 1024, v0
    v_mul_hi_u32 v10, v9, s87
    v_mul_u32_u24 v11, 6, v10
    v_sub_u32 v11, v9, v11
    v_mul_lo_u32 v6, v10, s91
    v_lshl_add_u32 v6, v11, 4, v6
    v_add_u32 v6, s92, v6
    s_add_u32 m0, s88, 16384
    s_nop 0
    global_load_lds_dwordx4 v6, s[8:9]
    v_add_u32 v9, 1280, v0
    v_mul_hi_u32 v10, v9, s87
    v_mul_u32_u24 v11, 6, v10
    v_sub_u32 v11, v9, v11
    v_mul_lo_u32 v6, v10, s91
    v_lshl_add_u32 v6, v11, 4, v6
    v_add_u32 v6, s92, v6
    s_add_u32 m0, s88, 20480
    s_nop 0
    global_load_lds_dwordx4 v6, s[8:9]
    v_add_u32 v9, 1536, v0
    v_mul_hi_u32 v10, v9, s87
    v_mul_u32_u24 v11, 6, v10
    v_sub_u32 v11, v9, v11
    v_mul_lo_u32 v6, v10, s91
    v_lshl_add_u32 v6, v11, 4, v6
    v_add_u32 v6, s92, v6
    s_add_u32 m0, s88, 24576
    s_nop 0
    global_load_lds_dwordx4 v6, s[8:9]
    v_add_u32 v9, 1792, v0
    v_mul_hi_u32 v10, v9, s87
    v_mul_u32_u24 v11, 6, v10
    v_sub_u32 v11, v9, v11
    v_mul_lo_u32 v6, v10, s91
    v_lshl_add_u32 v6, v11, 4, v6
    v_add_u32 v6, s92, v6
    s_add_u32 m0, s88, 28672
    s_nop 0
    global_load_lds_dwordx4 v6, s[8:9]
    v_add_u32 v9, 2048, v0
    v_mul_hi_u32 v10, v9, s87
    v_mul_u32_u24 v11, 6, v10
    v_sub_u32 v11, v9, v11
    v_mul_lo_u32 v6, v10, s91
    v_lshl_add_u32 v6, v11, 4, v6
    v_add_u32 v6, s92, v6
    s_add_u32 m0, s88, 32768
    s_nop 0
    global_load_lds_dwordx4 v6, s[8:9]
    v_add_u32 v9, 2304, v0
    v_mul_hi_u32 v10, v9, s87
    v_mul_u32_u24 v11, 6, v10
    v_sub_u32 v11, v9, v11
    v_mul_lo_u32 v6, v10, s91
    v_lshl_add_u32 v6, v11, 4, v6
    v_add_u32 v6, s92, v6
    s_add_u32 m0, s88, 36864
    s_nop 0
    global_load_lds_dwordx4 v6, s[8:9]
    v_add_u32 v9, 2560, v0
    v_mul_hi_u32 v10, v9, s87
    v_mul_u32_u24 v11, 6, v10
    v_sub_u32 v11, v9, v11
    v_mul_lo_u32 v6, v10, s91
    v_lshl_add_u32 v6, v11, 4, v6
    v_add_u32 v6, s92, v6
    s_add_u32 m0, s88, 40960
    s_nop 0
    global_load_lds_dwordx4 v6, s[8:9]
    v_add_u32 v9, 2816, v0
    v_mul_hi_u32 v10, v9, s87
    v_mul_u32_u24 v11, 6, v10
    v_sub_u32 v11, v9, v11
    v_mul_lo_u32 v6, v10, s91
    v_lshl_add_u32 v6, v11, 4, v6
    v_add_u32 v6, s92, v6
    s_add_u32 m0, s88, 45056
    s_nop 0
    global_load_lds_dwordx4 v6, s[8:9]
    v_add_u32 v9, 3072, v0
    v_mul_hi_u32 v10, v9, s87
    v_mul_u32_u24 v11, 6, v10
    v_sub_u32 v11, v9, v11
    v_mul_lo_u32 v6, v10, s91
    v_lshl_add_u32 v6, v11, 4, v6
    v_add_u32 v6, s92, v6
    s_add_u32 m0, s88, 49152
    s_nop 0
    global_load_lds_dwordx4 v6, s[8:9]
    s_cmp_lt_u32 s89, 2
    s_cbranch_scc0 K1QP_B13
    v_add_u32 v9, 3328, v0
    v_mul_hi_u32 v10, v9, s87
    v_mul_u32_u24 v11, 6, v10
    v_sub_u32 v11, v9, v11
    v_mul_lo_u32 v6, v10, s91
    v_lshl_add_u32 v6, v11, 4, v6
    v_add_u32 v6, s92, v6
    s_add_u32 m0, s88, 53248
    s_nop 0
    global_load_lds_dwordx4 v6, s[8:9]
K1QP_B13:
    global_load_dwordx4 v[64:67], v5, s[4:5] offset:0
    global_load_dwordx4 v[68:71], v7, s[4:5] offset:0
    global_load_dwordx4 v[72:75], v5, s[4:5] offset:64
    global_load_dwordx4 v[76:79], v7, s[4:5] offset:64
    global_load_dwordx4 v[80:83], v5, s[4:5] offset:128
    global_load_dwordx4 v[84:87], v7, s[4:5] offset:128
    global_load_dwordx4 v[88:91], v5, s[4:5] offset:192
    global_load_dwordx4 v[92:95], v7, s[4:5] offset:192
    global_load_dwordx4 v[96:99], v5, s[4:5] offset:256
    global_load_dwordx4 v[100:103], v7, s[4:5] offset:256
    global_load_dwordx4 v[104:107], v5, s[4:5] offset:320
    global_load_dwordx4 v[108:111], v7, s[4:5] offset:320
    v_lshrrev_b32 v10, 2, v3
    v_lshl_add_u32 v10, v2, 3, v10
    v_mul_u32_u24 v8, 96, v10
    v_and_b32 v9, 3, v3
    v_lshl_add_u32 v8, v9, 3, v8
    s_mov_b32 s87, 715827883
    s_lshl_b32 s92, s13, 1
    s_waitcnt vmcnt(12)
    s_barrier
    ds_read_b64_tr_b16 v[16:17], v8 offset:0
    ds_read_b64_tr_b16 v[18:19], v8 offset:384
    ds_read_b64_tr_b16 v[20:21], v8 offset:32
    ds_read_b64_tr_b16 v[22:23], v8 offset:416
    ds_read_b64_tr_b16 v[24:25], v8 offset:64
    ds_read_b64_tr_b16 v[26:27], v8 offset:448
    ds_read_b64_tr_b16 v[28:29], v8 offset:3072
    ds_read_b64_tr_b16 v[30:31], v8 offset:3456
    ds_read_b64_tr_b16 v[32:33], v8 offset:3104
    ds_read_b64_tr_b16 v[34:35], v8 offset:3488
    ds_read_b64_tr_b16 v[36:37], v8 offset:3136
    ds_read_b64_tr_b16 v[38:39], v8 offset:3520
    global_load_dwordx4 v[112:115], v5, s[4:5] offset:384
    global_load_dwordx4 v[116:119], v7, s[4:5] offset:384
    s_waitcnt vmcnt(12) lgkmcnt(6)
    v_mfma_f32_16x16x32_bf16 v[40:43], v[64:67], v[16:19], 0
    v_mfma_f32_16x16x32_bf16 v[44:47], v[64:67], v[20:23], 0
    v_mfma_f32_16x16x32_bf16 v[48:51], v[64:67], v[24:27], 0
    v_mfma_f32_16x16x32_bf16 v[52:55], v[68:71], v[16:19], 0
    v_mfma_f32_16x16x32_bf16 v[56:59], v[68:71], v[20:23], 0
    v_mfma_f32_16x16x32_bf16 v[60:63], v[68:71], v[24:27], 0
    ds_read_b64_tr_b16 v[16:17], v8 offset:6144
    ds_read_b64_tr_b16 v[18:19], v8 offset:6528
    ds_read_b64_tr_b16 v[20:21], v8 offset:6176
    ds_read_b64_tr_b16 v[22:23], v8 offset:6560
    ds_read_b64_tr_b16 v[24:25], v8 offset:6208
    ds_read_b64_tr_b16 v[26:27], v8 offset:6592
    global_load_dwordx4 v[120:123], v5, s[4:5] offset:448
    global_load_dwordx4 v[124:127], v7, s[4:5] offset:448
    s_waitcnt vmcnt(12) lgkmcnt(6)
    v_mfma_f32_16x16x32_bf16 v[40:43], v[72:75], v[28:31], v[40:43]
    v_mfma_f32_16x16x32_bf16 v[44:47], v[72:75], v[32:35], v[44:47]
    v_mfma_f32_16x16x32_bf16 v[48:51], v[72:75], v[36:39], v[48:51]
    v_mfma_f32_16x16x32_bf16 v[52:55], v[76:79], v[28:31], v[52:55]
    v_mfma_f32_16x16x32_bf16 v[56:59], v[76:79], v[32:35], v[56:59]
    v_mfma_f32_16x16x32_bf16 v[60:63], v[76:79], v[36:39], v[60:63]
    ds_read_b64_tr_b16 v[28:29], v8 offset:9216
    ds_read_b64_tr_b16 v[30:31], v8 offset:9600
    ds_read_b64_tr_b16 v[32:33], v8 offset:9248
    ds_read_b64_tr_b16 v[34:35], v8 offset:9632
    ds_read_b64_tr_b16 v[36:37], v8 offset:9280
    ds_read_b64_tr_b16 v[38:39], v8 offset:9664
    global_load_dwordx4 v[128:131], v5, s[4:5] offset:512
    global_load_dwordx4 v[132:135], v7, s[4:5] offset:512
    s_waitcnt vmcnt(12) lgkmcnt(6)
    v_mfma_f32_16x16x32_bf16 v[40:43], v[80:83], v[16:19], v[40:43]
    v_mfma_f32_16x16x32_bf16 v[44:47], v[80:83], v[20:23], v[44:47]
    v_mfma_f32_16x16x32_bf16 v[48:51], v[80:83], v[24:27], v[48:51]
    v_mfma_f32_16x16x32_bf16 v[52:55], v[84:87], v[16:19], v[52:55]
    v_mfma_f32_16x16x32_bf16 v[56:59], v[84:87], v[20:23], v[56:59]
    v_mfma_f32_16x16x32_bf16 v[60:63], v[84:87], v[24:27], v[60:63]
    ds_read_b64_tr_b16 v[16:17], v8 offset:12288
    ds_read_b64_tr_b16 v[18:19], v8 offset:12672
    ds_read_b64_tr_b16 v[20:21], v8 offset:12320
    ds_read_b64_tr_b16 v[22:23], v8 offset:12704
    ds_read_b64_tr_b16 v[24:25], v8 offset:12352
    ds_read_b64_tr_b16 v[26:27], v8 offset:12736
    global_load_dwordx4 v[136:139], v5, s[4:5] offset:576
    global_load_dwordx4 v[140:143], v7, s[4:5] offset:576
    s_waitcnt vmcnt(12) lgkmcnt(6)
    v_mfma_f32_16x16x32_bf16 v[40:43], v[88:91], v[28:31], v[40:43]
    v_mfma_f32_16x16x32_bf16 v[44:47], v[88:91], v[32:35], v[44:47]
    v_mfma_f32_16x16x32_bf16 v[48:51], v[88:91], v[36:39], v[48:51]
    v_mfma_f32_16x16x32_bf16 v[52:55], v[92:95], v[28:31], v[52:55]
    v_mfma_f32_16x16x32_bf16 v[56:59], v[92:95], v[32:35], v[56:59]
    v_mfma_f32_16x16x32_bf16 v[60:63], v[92:95], v[36:39], v[60:63]
    ds_read_b64_tr_b16 v[28:29], v8 offset:15360
    ds_read_b64_tr_b16 v[30:31], v8 offset:15744
    ds_read_b64_tr_b16 v[32:33], v8 offset:15392
    ds_read_b64_tr_b16 v[34:35], v8 offset:15776
    ds_read_b64_tr_b16 v[36:37], v8 offset:15424
    ds_read_b64_tr_b16 v[38:39], v8 offset:15808
    global_load_dwordx4 v[144:147], v5, s[4:5] offset:640
    global_load_dwordx4 v[148:151], v7, s[4:5] offset:640
    s_waitcnt vmcnt(12) lgkmcnt(6)
    v_mfma_f32_16x16x32_bf16 v[40:43], v[96:99], v[16:19], v[40:43]
    v_mfma_f32_16x16x32_bf16 v[44:47], v[96:99], v[20:23], v[44:47]
    v_mfma_f32_16x16x32_bf16 v[48:51], v[96:99], v[24:27], v[48:51]
    v_mfma_f32_16x16x32_bf16 v[52:55], v[100:103], v[16:19], v[52:55]
    v_mfma_f32_16x16x32_bf16 v[56:59], v[100:103], v[20:23], v[56:59]
    v_mfma_f32_16x16x32_bf16 v[60:63], v[100:103], v[24:27], v[60:63]
    ds_read_b64_tr_b16 v[16:17], v8 offset:18432
    ds_read_b64_tr_b16 v[18:19], v8 offset:18816
    ds_read_b64_tr_b16 v[20:21], v8 offset:18464
    ds_read_b64_tr_b16 v[22:23], v8 offset:18848
    ds_read_b64_tr_b16 v[24:25], v8 offset:18496
    ds_read_b64_tr_b16 v[26:27], v8 offset:18880
    global_load_dwordx4 v[152:155], v5, s[4:5] offset:704
    global_load_dwordx4 v[156:159], v7, s[4:5] offset:704
    s_waitcnt vmcnt(12) lgkmcnt(6)
    v_mfma_f32_16x16x32_bf16 v[40:43], v[104:107], v[28:31], v[40:43]
    v_mfma_f32_16x16x32_bf16 v[44:47], v[104:107], v[32:35], v[44:47]
    v_mfma_f32_16x16x32_bf16 v[48:51], v[104:107], v[36:39], v[48:51]
    v_mfma_f32_16x16x32_bf16 v[52:55], v[108:111], v[28:31], v[52:55]
    v_mfma_f32_16x16x32_bf16 v[56:59], v[108:111], v[32:35], v[56:59]
    v_mfma_f32_16x16x32_bf16 v[60:63], v[108:111], v[36:39], v[60:63]
    ds_read_b64_tr_b16 v[28:29], v8 offset:21504
    ds_read_b64_tr_b16 v[30:31], v8 offset:21888
    ds_read_b64_tr_b16 v[32:33], v8 offset:21536
    ds_read_b64_tr_b16 v[34:35], v8 offset:21920
    ds_read_b64_tr_b16 v[36:37], v8 offset:21568
    ds_read_b64_tr_b16 v[38:39], v8 offset:21952
    global_load_dwordx4 v[160:163], v5, s[4:5] offset:768
    global_load_dwordx4 v[164:167], v7, s[4:5] offset:768
    s_waitcnt vmcnt(12) lgkmcnt(6)
    v_mfma_f32_16x16x32_bf16 v[40:43], v[112:115], v[16:19], v[40:43]
    v_mfma_f32_16x16x32_bf16 v[44:47], v[112:115], v[20:23], v[44:47]
    v_mfma_f32_16x16x32_bf16 v[48:51], v[112:115], v[24:27], v[48:51]
    v_mfma_f32_16x16x32_bf16 v[52:55], v[116:119], v[16:19], v[52:55]
    v_mfma_f32_16x16x32_bf16 v[56:59], v[116:119], v[20:23], v[56:59]
    v_mfma_f32_16x16x32_bf16 v[60:63], v[116:119], v[24:27], v[60:63]
    ds_read_b64_tr_b16 v[16:17], v8 offset:24576
    ds_read_b64_tr_b16 v[18:19], v8 offset:24960
    ds_read_b64_tr_b16 v[20:21], v8 offset:24608
    ds_read_b64_tr_b16 v[22:23], v8 offset:24992
    ds_read_b64_tr_b16 v[24:25], v8 offset:24640
    ds_read_b64_tr_b16 v[26:27], v8 offset:25024
    global_load_dwordx4 v[168:171], v5, s[4:5] offset:832
    global_load_dwordx4 v[172:175], v7, s[4:5] offset:832
    s_waitcnt vmcnt(12) lgkmcnt(6)
    v_mfma_f32_16x16x32_bf16 v[40:43], v[120:123], v[28:31], v[40:43]
    v_mfma_f32_16x16x32_bf16 v[44:47], v[120:123], v[32:35], v[44:47]
    v_mfma_f32_16x16x32_bf16 v[48:51], v[120:123], v[36:39], v[48:51]
    v_mfma_f32_16x16x32_bf16 v[52:55], v[124:127], v[28:31], v[52:55]
    v_mfma_f32_16x16x32_bf16 v[56:59], v[124:127], v[32:35], v[56:59]
    v_mfma_f32_16x16x32_bf16 v[60:63], v[124:127], v[36:39], v[60:63]
    ds_read_b64_tr_b16 v[28:29], v8 offset:27648
    ds_read_b64_tr_b16 v[30:31], v8 offset:28032
    ds_read_b64_tr_b16 v[32:33], v8 offset:27680
    ds_read_b64_tr_b16 v[34:35], v8 offset:28064
    ds_read_b64_tr_b16 v[36:37], v8 offset:27712
    ds_read_b64_tr_b16 v[38:39], v8 offset:28096
    global_load_dwordx4 v[176:179], v5, s[4:5] offset:896
    global_load_dwordx4 v[180:183], v7, s[4:5] offset:896
    s_waitcnt vmcnt(12) lgkmcnt(6)
    v_mfma_f32_16x16x32_bf16 v[40:43], v[128:131], v[16:19], v[40:43]
    v_mfma_f32_16x16x32_bf16 v[44:47], v[128:131], v[20:23], v[44:47]
    v_mfma_f32_16x16x32_bf16 v[48:51], v[128:131], v[24:27], v[48:51]
    v_mfma_f32_16x16x32_bf16 v[52:55], v[132:135], v[16:19], v[52:55]
    v_mfma_f32_16x16x32_bf16 v[56:59], v[132:135], v[20:23], v[56:59]
    v_mfma_f32_16x16x32_bf16 v[60:63], v[132:135], v[24:27], v[60:63]
    ds_read_b64_tr_b16 v[16:17], v8 offset:30720
    ds_read_b64_tr_b16 v[18:19], v8 offset:31104
    ds_read_b64_tr_b16 v[20:21], v8 offset:30752
    ds_read_b64_tr_b16 v[22:23], v8 offset:31136
    ds_read_b64_tr_b16 v[24:25], v8 offset:30784
    ds_read_b64_tr_b16 v[26:27], v8 offset:31168
    global_load_dwordx4 v[184:187], v5, s[4:5] offset:960
    global_load_dwordx4 v[188:191], v7, s[4:5] offset:960
    s_waitcnt vmcnt(12) lgkmcnt(6)
    v_mfma_f32_16x16x32_bf16 v[40:43], v[136:139], v[28:31], v[40:43]
    v_mfma_f32_16x16x32_bf16 v[44:47], v[136:139], v[32:35], v[44:47]
    v_mfma_f32_16x16x32_bf16 v[48:51], v[136:139], v[36:39], v[48:51]
    v_mfma_f32_16x16x32_bf16 v[52:55], v[140:143], v[28:31], v[52:55]
    v_mfma_f32_16x16x32_bf16 v[56:59], v[140:143], v[32:35], v[56:59]
    v_mfma_f32_16x16x32_bf16 v[60:63], v[140:143], v[36:39], v[60:63]
    ds_read_b64_tr_b16 v[28:29], v8 offset:33792
    ds_read_b64_tr_b16 v[30:31], v8 offset:34176
    ds_read_b64_tr_b16 v[32:33], v8 offset:33824
    ds_read_b64_tr_b16 v[34:35], v8 offset:34208
    ds_read_b64_tr_b16 v[36:37], v8 offset:33856
    ds_read_b64_tr_b16 v[38:39], v8 offset:34240
    global_load_dwordx4 v[192:195], v5, s[4:5] offset:1024
    global_load_dwordx4 v[196:199], v7, s[4:5] offset:1024
    s_waitcnt vmcnt(12) lgkmcnt(6)
    v_mfma_f32_16x16x32_bf16 v[40:43], v[144:147], v[16:19], v[40:43]
    v_mfma_f32_16x16x32_bf16 v[44:47], v[144:147], v[20:23], v[44:47]
    v_mfma_f32_16x16x32_bf16 v[48:51], v[144:147], v[24:27], v[48:51]
    v_mfma_f32_16x16x32_bf16 v[52:55], v[148:151], v[16:19], v[52:55]
    v_mfma_f32_16x16x32_bf16 v[56:59], v[148:151], v[20:23], v[56:59]
    v_mfma_f32_16x16x32_bf16 v[60:63], v[148:151], v[24:27], v[60:63]
    ds_read_b64_tr_b16 v[16:17], v8 offset:36864
    ds_read_b64_tr_b16 v[18:19], v8 offset:37248
    ds_read_b64_tr_b16 v[20:21], v8 offset:36896
    ds_read_b64_tr_b16 v[22:23], v8 offset:37280
    ds_read_b64_tr_b16 v[24:25], v8 offset:36928
    ds_read_b64_tr_b16 v[26:27], v8 offset:37312
    global_load_dwordx4 v[200:203], v5, s[4:5] offset:1088
    global_load_dwordx4 v[204:207], v7, s[4:5] offset:1088
    s_waitcnt vmcnt(12) lgkmcnt(6)
    v_mfma_f32_16x16x32_bf16 v[40:43], v[152:155], v[28:31], v[40:43]
    v_mfma_f32_16x16x32_bf16 v[44:47], v[152:155], v[32:35], v[44:47]
    v_mfma_f32_16x16x32_bf16 v[48:51], v[152:155], v[36:39], v[48:51]
    v_mfma_f32_16x16x32_bf16 v[52:55], v[156:159], v[28:31], v[52:55]
    v_mfma_f32_16x16x32_bf16 v[56:59], v[156:159], v[32:35], v[56:59]
    v_mfma_f32_16x16x32_bf16 v[60:63], v[156:159], v[36:39], v[60:63]
    ds_read_b64_tr_b16 v[28:29], v8 offset:39936
    ds_read_b64_tr_b16 v[30:31], v8 offset:40320
    ds_read_b64_tr_b16 v[32:33], v8 offset:39968
    ds_read_b64_tr_b16 v[34:35], v8 offset:40352
    ds_read_b64_tr_b16 v[36:37], v8 offset:40000
    ds_read_b64_tr_b16 v[38:39], v8 offset:40384
    v_add_u32 v13, 0, v1
    v_mul_hi_u32 v14, v13, s87
    v_mul_u32_u24 v15, 6, v14
    v_sub_u32 v15, v13, v15
    v_lshl_add_u32 v13, v4, 5, v14
    v_add_u32 v13, s12, v13
    v_mul_lo_u32 v13, v13, s91
    v_lshl_add_u32 v13, v15, 4, v13
    v_add_u32 v13, s92, v13
    global_load_dwordx4 v[208:211], v13, s[4:5]
    v_add_u32 v13, 64, v1
    v_mul_hi_u32 v14, v13, s87
    v_mul_u32_u24 v15, 6, v14
    v_sub_u32 v15, v13, v15
    v_lshl_add_u32 v13, v4, 5, v14
    v_add_u32 v13, s12, v13
    v_mul_lo_u32 v13, v13, s91
    v_lshl_add_u32 v13, v15, 4, v13
    v_add_u32 v13, s92, v13
    global_load_dwordx4 v[212:215], v13, s[4:5]
    v_add_u32 v13, 128, v1
    v_mul_hi_u32 v14, v13, s87
    v_mul_u32_u24 v15, 6, v14
    v_sub_u32 v15, v13, v15
    v_lshl_add_u32 v13, v4, 5, v14
    v_add_u32 v13, s12, v13
    v_mul_lo_u32 v13, v13, s91
    v_lshl_add_u32 v13, v15, 4, v13
    v_add_u32 v13, s92, v13
    global_load_dwordx4 v[216:219], v13, s[4:5]
    s_waitcnt vmcnt(13) lgkmcnt(6)
    v_mfma_f32_16x16x32_bf16 v[40:43], v[160:163], v[16:19], v[40:43]
    v_mfma_f32_16x16x32_bf16 v[44:47], v[160:163], v[20:23], v[44:47]
    v_mfma_f32_16x16x32_bf16 v[48:51], v[160:163], v[24:27], v[48:51]
    v_mfma_f32_16x16x32_bf16 v[52:55], v[164:167], v[16:19], v[52:55]
    v_mfma_f32_16x16x32_bf16 v[56:59], v[164:167], v[20:23], v[56:59]
    v_mfma_f32_16x16x32_bf16 v[60:63], v[164:167], v[24:27], v[60:63]
    ds_read_b64_tr_b16 v[16:17], v8 offset:43008
    ds_read_b64_tr_b16 v[18:19], v8 offset:43392
    ds_read_b64_tr_b16 v[20:21], v8 offset:43040
    ds_read_b64_tr_b16 v[22:23], v8 offset:43424
    ds_read_b64_tr_b16 v[24:25], v8 offset:43072
    ds_read_b64_tr_b16 v[26:27], v8 offset:43456
    s_waitcnt vmcnt(11) lgkmcnt(6)
    v_mfma_f32_16x16x32_bf16 v[40:43], v[168:171], v[28:31], v[40:43]
    v_mfma_f32_16x16x32_bf16 v[44:47], v[168:171], v[32:35], v[44:47]
    v_mfma_f32_16x16x32_bf16 v[48:51], v[168:171], v[36:39], v[48:51]
    v_mfma_f32_16x16x32_bf16 v[52:55], v[172:175], v[28:31], v[52:55]
    v_mfma_f32_16x16x32_bf16 v[56:59], v[172:175], v[32:35], v[56:59]
    v_mfma_f32_16x16x32_bf16 v[60:63], v[172:175], v[36:39], v[60:63]
    ds_read_b64_tr_b16 v[28:29], v8 offset:46080
    ds_read_b64_tr_b16 v[30:31], v8 offset:46464
    ds_read_b64_tr_b16 v[32:33], v8 offset:46112
    ds_read_b64_tr_b16 v[34:35], v8 offset:46496
    ds_read_b64_tr_b16 v[36:37], v8 offset:46144
    ds_read_b64_tr_b16 v[38:39], v8 offset:46528
    s_waitcnt vmcnt(9) lgkmcnt(6)
    v_mfma_f32_16x16x32_bf16 v[40:43], v[176:179], v[16:19], v[40:43]
    v_mfma_f32_16x16x32_bf16 v[44:47], v[176:179], v[20:23], v[44:47]
    v_mfma_f32_16x16x32_bf16 v[48:51], v[176:179], v[24:27], v[48:51]
    v_mfma_f32_16x16x32_bf16 v[52:55], v[180:183], v[16:19], v[52:55]
    v_mfma_f32_16x16x32_bf16 v[56:59], v[180:183], v[20:23], v[56:59]
    v_mfma_f32_16x16x32_bf16 v[60:63], v[180:183], v[24:27], v[60:63]
    ds_read_b64_tr_b16 v[16:17], v8 offset:49152
    ds_read_b64_tr_b16 v[18:19], v8 offset:49536
    ds_read_b64_tr_b16 v[20:21], v8 offset:49184
    ds_read_b64_tr_b16 v[22:23], v8 offset:49568
    ds_read_b64_tr_b16 v[24:25], v8 offset:49216
    ds_read_b64_tr_b16 v[26:27], v8 offset:49600
    s_waitcnt vmcnt(7) lgkmcnt(6)
    v_mfma_f32_16x16x32_bf16 v[40:43], v[184:187], v[28:31], v[40:43]
    v_mfma_f32_16x16x32_bf16 v[44:47], v[184:187], v[32:35], v[44:47]
    v_mfma_f32_16x16x32_bf16 v[48:51], v[184:187], v[36:39], v[48:51]
    v_mfma_f32_16x16x32_bf16 v[52:55], v[188:191], v[28:31], v[52:55]
    v_mfma_f32_16x16x32_bf16 v[56:59], v[188:191], v[32:35], v[56:59]
    v_mfma_f32_16x16x32_bf16 v[60:63], v[188:191], v[36:39], v[60:63]
    ds_read_b64_tr_b16 v[28:29], v8 offset:52224
    ds_read_b64_tr_b16 v[30:31], v8 offset:52608
    ds_read_b64_tr_b16 v[32:33], v8 offset:52256
    ds_read_b64_tr_b16 v[34:35], v8 offset:52640
    ds_read_b64_tr_b16 v[36:37], v8 offset:52288
    ds_read_b64_tr_b16 v[38:39], v8 offset:52672
    s_waitcnt vmcnt(5) lgkmcnt(6)
    v_mfma_f32_16x16x32_bf16 v[40:43], v[192:195], v[16:19], v[40:43]
    v_mfma_f32_16x16x32_bf16 v[44:47], v[192:195], v[20:23], v[44:47]
    v_mfma_f32_16x16x32_bf16 v[48:51], v[192:195], v[24:27], v[48:51]
    v_mfma_f32_16x16x32_bf16 v[52:55], v[196:199], v[16:19], v[52:55]
    v_mfma_f32_16x16x32_bf16 v[56:59], v[196:199], v[20:23], v[56:59]
    v_mfma_f32_16x16x32_bf16 v[60:63], v[196:199], v[24:27], v[60:63]
    s_waitcnt vmcnt(3) lgkmcnt(0)
    v_mfma_f32_16x16x32_bf16 v[40:43], v[200:203], v[28:31], v[40:43]
    v_mfma_f32_16x16x32_bf16 v[44:47], v[200:203], v[32:35], v[44:47]
    v_mfma_f32_16x16x32_bf16 v[48:51], v[200:203], v[36:39], v[48:51]
    v_mfma_f32_16x16x32_bf16 v[52:55], v[204:207], v[28:31], v[52:55]
    v_mfma_f32_16x16x32_bf16 v[56:59], v[204:207], v[32:35], v[56:59]
    v_mfma_f32_16x16x32_bf16 v[60:63], v[204:207], v[36:39], v[60:63]
    s_nop 15
    v_mul_u32_u24 v9, 3072, v4
    v_add_u32 v9, s86, v9
    v_lshl_add_u32 v10, v1, 4, v9
    s_waitcnt vmcnt(0)
    ds_write_b128 v10, v[208:211] offset:0
    ds_write_b128 v10, v[212:215] offset:1024
    ds_write_b128 v10, v[216:219] offset:2048
    v_lshrrev_b32 v11, 2, v3
    v_mul_u32_u24 v11, 96, v11
    v_lshl_add_u32 v11, v2, 5, v11
    v_and_b32 v12, 3, v3
    v_lshl_add_u32 v11, v12, 3, v11
    v_add_u32 v11, v9, v11
    s_waitcnt lgkmcnt(0)
    ds_read_b64_tr_b16 v[64:65], v11 offset:0
    ds_read_b64_tr_b16 v[66:67], v11 offset:384
    ds_read_b64_tr_b16 v[68:69], v11 offset:768
    ds_read_b64_tr_b16 v[70:71], v11 offset:1152
    ds_read_b64_tr_b16 v[72:73], v11 offset:1536
    ds_read_b64_tr_b16 v[74:75], v11 offset:1920
    ds_read_b64_tr_b16 v[76:77], v11 offset:2304
    ds_read_b64_tr_b16 v[78:79], v11 offset:2688
    s_add_u32 s16, s6, 12124160
    s_addc_u32 s17, s7, 0
    v_lshl_add_u32 v12, v2, 4, v3
    v_add_u32 v12, s13, v12
    v_lshlrev_b32 v12, 12, v12
    v_lshlrev_b32 v10, 5, v4
    v_add_u32 v10, s12, v10
    v_lshl_add_u32 v12, v10, 1, v12
    v_cmp_gt_u32 vcc, 3, v2
    s_waitcnt lgkmcnt(0)
    s_and_saveexec_b64 s[20:21], vcc
    global_store_dwordx4 v12, v[64:67], s[16:17] offset:0
    global_store_dwordx4 v12, v[68:71], s[16:17] offset:16
    global_store_dwordx4 v12, v[72:75], s[16:17] offset:32
    global_store_dwordx4 v12, v[76:79], s[16:17] offset:48
    s_mov_b64 exec, s[20:21]
    s_add_u32 s16, s6, 0
    s_addc_u32 s17, s7, 0
    s_mov_b32 s93, 1051597459
    v_mul_f32 v40, s93, v40
    v_mul_f32 v41, s93, v41
    v_mul_f32 v42, s93, v42
    v_mul_f32 v43, s93, v43
    v_mul_f32 v44, s93, v44
    v_mul_f32 v45, s93, v45
    v_mul_f32 v46, s93, v46
    v_mul_f32 v47, s93, v47
    v_mul_f32 v48, s93, v48
    v_mul_f32 v49, s93, v49
    v_mul_f32 v50, s93, v50
    v_mul_f32 v51, s93, v51
    v_mul_f32 v52, s93, v52
    v_mul_f32 v53, s93, v53
    v_mul_f32 v54, s93, v54
    v_mul_f32 v55, s93, v55
    v_mul_f32 v56, s93, v56
    v_mul_f32 v57, s93, v57
    v_mul_f32 v58, s93, v58
    v_mul_f32 v59, s93, v59
    v_mul_f32 v60, s93, v60
    v_mul_f32 v61, s93, v61
    v_mul_f32 v62, s93, v62
    v_mul_f32 v63, s93, v63
    v_mul_u32_u24 v9, 3072, v4
    v_mul_u32_u24 v10, 384, v2
    v_add3_u32 v9, v9, v10, s86
    v_lshl_add_u32 v10, v3, 1, v9
    v_cvt_pk_bf16_f32 v40, v40, v41
    v_cvt_pk_bf16_f32 v42, v42, v43
    ds_write_b16 v10, v40 offset:0
    ds_write_b16_d16_hi v10, v40 offset:96
    ds_write_b16 v10, v42 offset:192
    ds_write_b16_d16_hi v10, v42 offset:288
    v_cvt_pk_bf16_f32 v44, v44, v45
    v_cvt_pk_bf16_f32 v46, v46, v47
    ds_write_b16 v10, v44 offset:32
    ds_write_b16_d16_hi v10, v44 offset:128
    ds_write_b16 v10, v46 offset:224
    ds_write_b16_d16_hi v10, v46 offset:320
    v_cvt_pk_bf16_f32 v48, v48, v49
    v_cvt_pk_bf16_f32 v50, v50, v51
    ds_write_b16 v10, v48 offset:64
    ds_write_b16_d16_hi v10, v48 offset:160
    ds_write_b16 v10, v50 offset:256
    ds_write_b16_d16_hi v10, v50 offset:352
    v_cvt_pk_bf16_f32 v52, v52, v53
    v_cvt_pk_bf16_f32 v54, v54, v55
    ds_write_b16 v10, v52 offset:1536
    ds_write_b16_d16_hi v10, v52 offset:1632
    ds_write_b16 v10, v54 offset:1728
    ds_write_b16_d16_hi v10, v54 offset:1824
    v_cvt_pk_bf16_f32 v56, v56, v57
    v_cvt_pk_bf16_f32 v58, v58, v59
    ds_write_b16 v10, v56 offset:1568
    ds_write_b16_d16_hi v10, v56 offset:1664
    ds_write_b16 v10, v58 offset:1760
    ds_write_b16_d16_hi v10, v58 offset:1856
    v_cvt_pk_bf16_f32 v60, v60, v61
    v_cvt_pk_bf16_f32 v62, v62, v63
    ds_write_b16 v10, v60 offset:1600
    ds_write_b16_d16_hi v10, v60 offset:1696
    ds_write_b16 v10, v62 offset:1792
    ds_write_b16_d16_hi v10, v62 offset:1888
    s_mov_b32 s87, 715827883
    v_mul_u32_u24 v9, 3072, v4
    v_add_u32 v9, s86, v9
    v_lshl_add_u32 v9, v1, 4, v9
    s_waitcnt lgkmcnt(0)
    ds_read_b128 v[64:67], v9 offset:0
    ds_read_b128 v[68:71], v9 offset:1024
    ds_read_b128 v[72:75], v9 offset:2048
    v_lshlrev_b32 v12, 5, v4
    v_add_u32 v12, s12, v12
    s_lshl_b32 s92, s13, 1
    v_add_u32 v9, 0, v1
    v_mul_hi_u32 v10, v9, s87
    v_mul_u32_u24 v11, 6, v10
    v_sub_u32 v11, v9, v11
    v_add_u32 v10, v12, v10
    v_mul_lo_u32 v10, v10, s91
    v_lshl_add_u32 v10, v11, 4, v10
    v_add_u32 v10, s92, v10
    s_waitcnt lgkmcnt(2)
    global_store_dwordx4 v10, v[64:67], s[16:17]
    v_add_u32 v9, 64, v1
    v_mul_hi_u32 v10, v9, s87
    v_mul_u32_u24 v11, 6, v10
    v_sub_u32 v11, v9, v11
    v_add_u32 v10, v12, v10
    v_mul_lo_u32 v10, v10, s91
    v_lshl_add_u32 v10, v11, 4, v10
    v_add_u32 v10, s92, v10
    s_waitcnt lgkmcnt(1)
    global_store_dwordx4 v10, v[68:71], s[16:17]
    v_add_u32 v9, 128, v1
    v_mul_hi_u32 v10, v9, s87
    v_mul_u32_u24 v11, 6, v10
    v_sub_u32 v11, v9, v11
    v_add_u32 v10, v12, v10
    v_mul_lo_u32 v10, v10, s91
    v_lshl_add_u32 v10, v11, 4, v10
    v_add_u32 v10, s92, v10
    s_waitcnt lgkmcnt(0)
    global_store_dwordx4 v10, v[72:75], s[16:17]
    s_endpgm
K1_KV:
    s_load_dwordx2 s[8:9], s[0:1], 72
    s_load_dwordx2 s[10:11], s[0:1], 80
    s_load_dwordx2 s[18:19], s[0:1], 96
    s_sub_u32 s3, s2, 480
    s_and_b32 s15, s3, 1
    s_lshr_b32 s12, s3, 1
    s_lshl_b32 s12, s12, 7
    v_and_b32 v1, 63, v0
    v_lshrrev_b32 v4, 6, v0
    v_lshrrev_b32 v2, 4, v1
    v_and_b32 v3, 15, v1
    s_movk_i32 s91, 1152
    v_readfirstlane_b32 s89, v4
    v_lshl_add_u32 v5, v4, 5, v3
    v_add_u32 v5, s12, v5
    v_mul_lo_u32 v5, v5, s91
    v_lshl_add_u32 v5, v2, 4, v5
    v_add_u32 v7, 18432, v5
    s_waitcnt lgkmcnt(0)
    s_cmp_eq_u32 s15, 0
    s_cselect_b32 s8, s8, s10
    s_cselect_b32 s9, s9, s11
    v_mov_b32 v12, s15
    v_cmp_eq_u32 s[24:25], 0, v12
    v_add_u32 v9, 0, v0
    v_mul_u32_u24 v10, 36, v9
    global_load_dwordx4 v[16:19], v10, s[8:9]
    global_load_dwordx4 v[20:23], v10, s[8:9] offset:16
    global_load_dword v24, v10, s[8:9] offset:32
    v_lshlrev_b32 v11, 1, v9
    global_load_ushort v25, v11, s[18:19]
    v_mov_b32 v26, 0
    v_mov_b32 v27, 0
    v_mov_b32 v28, 0
    v_mov_b32 v29, 0
    v_mov_b32 v30, 0
    v_mov_b32 v31, 0
    v_add_u32 v9, 256, v0
    v_mul_u32_u24 v10, 36, v9
    global_load_dwordx4 v[32:35], v10, s[8:9]
    global_load_dwordx4 v[36:39], v10, s[8:9] offset:16
    global_load_dword v40, v10, s[8:9] offset:32
    v_lshlrev_b32 v11, 1, v9
    global_load_ushort v41, v11, s[18:19]
    v_mov_b32 v42, 0
    v_mov_b32 v43, 0
    v_mov_b32 v44, 0
    v_mov_b32 v45, 0
    v_mov_b32 v46, 0
    v_mov_b32 v47, 0
    s_cmp_eq_u32 s89, 0
    s_cbranch_scc0 K1_KV_N3
    v_add_u32 v9, 512, v0
    v_mul_u32_u24 v10, 36, v9
    global_load_dwordx4 v[48:51], v10, s[8:9]
    global_load_dwordx4 v[52:55], v10, s[8:9] offset:16
    global_load_dword v56, v10, s[8:9] offset:32
    v_lshlrev_b32 v11, 1, v9
    global_load_ushort v57, v11, s[18:19]
    v_mov_b32 v58, 0
    v_mov_b32 v59, 0
    v_mov_b32 v60, 0
    v_mov_b32 v61, 0
    v_mov_b32 v62, 0
    v_mov_b32 v63, 0
    s_waitcnt vmcnt(0)
    v_cndmask_b32 v57, 0, v57, s[24:25]
    v_mul_u32_u24 v11, 96, v0
    ds_write_b128 v11, v[48:51] offset:49152
    ds_write_b128 v11, v[52:55] offset:49168
    ds_write_b128 v11, v[56:59] offset:49184
    ds_write_b128 v11, v[60:63] offset:49200
    ds_write_b128 v11, v[60:63] offset:49216
    ds_write_b128 v11, v[60:63] offset:49232
K1_KV_N3:
    s_waitcnt vmcnt(0)
    v_cndmask_b32 v25, 0, v25, s[24:25]
    v_mul_u32_u24 v11, 96, v0
    ds_write_b128 v11, v[16:19] offset:0
    ds_write_b128 v11, v[20:23] offset:16
    ds_write_b128 v11, v[24:27] offset:32
    ds_write_b128 v11, v[28:31] offset:48
    ds_write_b128 v11, v[28:31] offset:64
    ds_write_b128 v11, v[28:31] offset:80
    v_cndmask_b32 v41, 0, v41, s[24:25]
    v_mul_u32_u24 v11, 96, v0
    ds_write_b128 v11, v[32:35] offset:24576
    ds_write_b128 v11, v[36:39] offset:24592
    ds_write_b128 v11, v[40:43] offset:24608
    ds_write_b128 v11, v[44:47] offset:24624
    ds_write_b128 v11, v[44:47] offset:24640
    ds_write_b128 v11, v[44:47] offset:24656
    global_load_dwordx4 v[64:67], v5, s[4:5] offset:0
    global_load_dwordx4 v[68:71], v7, s[4:5] offset:0
    global_load_dwordx4 v[72:75], v5, s[4:5] offset:64
    global_load_dwordx4 v[76:79], v7, s[4:5] offset:64
    global_load_dwordx4 v[80:83], v5, s[4:5] offset:128
    global_load_dwordx4 v[84:87], v7, s[4:5] offset:128
    global_load_dwordx4 v[88:91], v5, s[4:5] offset:192
    global_load_dwordx4 v[92:95], v7, s[4:5] offset:192
    global_load_dwordx4 v[96:99], v5, s[4:5] offset:256
    global_load_dwordx4 v[100:103], v7, s[4:5] offset:256
    global_load_dwordx4 v[104:107], v5, s[4:5] offset:320
    global_load_dwordx4 v[108:111], v7, s[4:5] offset:320
    v_lshrrev_b32 v10, 2, v3
    v_lshl_add_u32 v10, v2, 3, v10
    v_mul_u32_u24 v8, 96, v10
    v_and_b32 v9, 3, v3
    v_lshl_add_u32 v8, v9, 3, v8
    s_waitcnt lgkmcnt(0)
    s_barrier
    s_lshr_b32 s13, s12, 5
    v_add_u32 v9, s13, v4
    v_lshrrev_b32 v10, 5, v9
    v_and_b32 v9, 31, v9
    s_mov_b32 s14, 81920
    v_mul_lo_u32 v13, v10, s14
    v_mov_b32 v14, v9
    s_add_u32 s16, s6, 4718592
    s_addc_u32 s17, s7, 0
    s_cmp_eq_u32 s15, 1
    s_cbranch_scc1 K1_KV_V
    ds_read_b64_tr_b16 v[16:17], v8 offset:0
    ds_read_b64_tr_b16 v[18:19], v8 offset:384
    ds_read_b64_tr_b16 v[20:21], v8 offset:32
    ds_read_b64_tr_b16 v[22:23], v8 offset:416
    ds_read_b64_tr_b16 v[24:25], v8 offset:64
    ds_read_b64_tr_b16 v[26:27], v8 offset:448
    ds_read_b64_tr_b16 v[28:29], v8 offset:3072
    ds_read_b64_tr_b16 v[30:31], v8 offset:3456
    ds_read_b64_tr_b16 v[32:33], v8 offset:3104
    ds_read_b64_tr_b16 v[34:35], v8 offset:3488
    ds_read_b64_tr_b16 v[36:37], v8 offset:3136
    ds_read_b64_tr_b16 v[38:39], v8 offset:3520
    global_load_dwordx4 v[112:115], v5, s[4:5] offset:384
    global_load_dwordx4 v[116:119], v7, s[4:5] offset:384
    s_waitcnt vmcnt(12) lgkmcnt(6)
    v_mfma_f32_16x16x32_bf16 v[40:43], v[16:19], v[64:67], 0
    v_mfma_f32_16x16x32_bf16 v[44:47], v[20:23], v[64:67], 0
    v_mfma_f32_16x16x32_bf16 v[48:51], v[24:27], v[64:67], 0
    v_mfma_f32_16x16x32_bf16 v[52:55], v[16:19], v[68:71], 0
    v_mfma_f32_16x16x32_bf16 v[56:59], v[20:23], v[68:71], 0
    v_mfma_f32_16x16x32_bf16 v[60:63], v[24:27], v[68:71], 0
    ds_read_b64_tr_b16 v[16:17], v8 offset:6144
    ds_read_b64_tr_b16 v[18:19], v8 offset:6528
    ds_read_b64_tr_b16 v[20:21], v8 offset:6176
    ds_read_b64_tr_b16 v[22:23], v8 offset:6560
    ds_read_b64_tr_b16 v[24:25], v8 offset:6208
    ds_read_b64_tr_b16 v[26:27], v8 offset:6592
    global_load_dwordx4 v[120:123], v5, s[4:5] offset:448
    global_load_dwordx4 v[124:127], v7, s[4:5] offset:448
    s_waitcnt vmcnt(12) lgkmcnt(6)
    v_mfma_f32_16x16x32_bf16 v[40:43], v[28:31], v[72:75], v[40:43]
    v_mfma_f32_16x16x32_bf16 v[44:47], v[32:35], v[72:75], v[44:47]
    v_mfma_f32_16x16x32_bf16 v[48:51], v[36:39], v[72:75], v[48:51]
    v_mfma_f32_16x16x32_bf16 v[52:55], v[28:31], v[76:79], v[52:55]
    v_mfma_f32_16x16x32_bf16 v[56:59], v[32:35], v[76:79], v[56:59]
    v_mfma_f32_16x16x32_bf16 v[60:63], v[36:39], v[76:79], v[60:63]
    ds_read_b64_tr_b16 v[28:29], v8 offset:9216
    ds_read_b64_tr_b16 v[30:31], v8 offset:9600
    ds_read_b64_tr_b16 v[32:33], v8 offset:9248
    ds_read_b64_tr_b16 v[34:35], v8 offset:9632
    ds_read_b64_tr_b16 v[36:37], v8 offset:9280
    ds_read_b64_tr_b16 v[38:39], v8 offset:9664
    global_load_dwordx4 v[128:131], v5, s[4:5] offset:512
    global_load_dwordx4 v[132:135], v7, s[4:5] offset:512
    s_waitcnt vmcnt(12) lgkmcnt(6)
    v_mfma_f32_16x16x32_bf16 v[40:43], v[16:19], v[80:83], v[40:43]
    v_mfma_f32_16x16x32_bf16 v[44:47], v[20:23], v[80:83], v[44:47]
    v_mfma_f32_16x16x32_bf16 v[48:51], v[24:27], v[80:83], v[48:51]
    v_mfma_f32_16x16x32_bf16 v[52:55], v[16:19], v[84:87], v[52:55]
    v_mfma_f32_16x16x32_bf16 v[56:59], v[20:23], v[84:87], v[56:59]
    v_mfma_f32_16x16x32_bf16 v[60:63], v[24:27], v[84:87], v[60:63]
    ds_read_b64_tr_b16 v[16:17], v8 offset:12288
    ds_read_b64_tr_b16 v[18:19], v8 offset:12672
    ds_read_b64_tr_b16 v[20:21], v8 offset:12320
    ds_read_b64_tr_b16 v[22:23], v8 offset:12704
    ds_read_b64_tr_b16 v[24:25], v8 offset:12352
    ds_read_b64_tr_b16 v[26:27], v8 offset:12736
    global_load_dwordx4 v[136:139], v5, s[4:5] offset:576
    global_load_dwordx4 v[140:143], v7, s[4:5] offset:576
    s_waitcnt vmcnt(12) lgkmcnt(6)
    v_mfma_f32_16x16x32_bf16 v[40:43], v[28:31], v[88:91], v[40:43]
    v_mfma_f32_16x16x32_bf16 v[44:47], v[32:35], v[88:91], v[44:47]
    v_mfma_f32_16x16x32_bf16 v[48:51], v[36:39], v[88:91], v[48:51]
    v_mfma_f32_16x16x32_bf16 v[52:55], v[28:31], v[92:95], v[52:55]
    v_mfma_f32_16x16x32_bf16 v[56:59], v[32:35], v[92:95], v[56:59]
    v_mfma_f32_16x16x32_bf16 v[60:63], v[36:39], v[92:95], v[60:63]
    ds_read_b64_tr_b16 v[28:29], v8 offset:15360
    ds_read_b64_tr_b16 v[30:31], v8 offset:15744
    ds_read_b64_tr_b16 v[32:33], v8 offset:15392
    ds_read_b64_tr_b16 v[34:35], v8 offset:15776
    ds_read_b64_tr_b16 v[36:37], v8 offset:15424
    ds_read_b64_tr_b16 v[38:39], v8 offset:15808
    global_load_dwordx4 v[144:147], v5, s[4:5] offset:640
    global_load_dwordx4 v[148:151], v7, s[4:5] offset:640
    s_waitcnt vmcnt(12) lgkmcnt(6)
    v_mfma_f32_16x16x32_bf16 v[40:43], v[16:19], v[96:99], v[40:43]
    v_mfma_f32_16x16x32_bf16 v[44:47], v[20:23], v[96:99], v[44:47]
    v_mfma_f32_16x16x32_bf16 v[48:51], v[24:27], v[96:99], v[48:51]
    v_mfma_f32_16x16x32_bf16 v[52:55], v[16:19], v[100:103], v[52:55]
    v_mfma_f32_16x16x32_bf16 v[56:59], v[20:23], v[100:103], v[56:59]
    v_mfma_f32_16x16x32_bf16 v[60:63], v[24:27], v[100:103], v[60:63]
    ds_read_b64_tr_b16 v[16:17], v8 offset:18432
    ds_read_b64_tr_b16 v[18:19], v8 offset:18816
    ds_read_b64_tr_b16 v[20:21], v8 offset:18464
    ds_read_b64_tr_b16 v[22:23], v8 offset:18848
    ds_read_b64_tr_b16 v[24:25], v8 offset:18496
    ds_read_b64_tr_b16 v[26:27], v8 offset:18880
    global_load_dwordx4 v[152:155], v5, s[4:5] offset:704
    global_load_dwordx4 v[156:159], v7, s[4:5] offset:704
    s_waitcnt vmcnt(12) lgkmcnt(6)
    v_mfma_f32_16x16x32_bf16 v[40:43], v[28:31], v[104:107], v[40:43]
    v_mfma_f32_16x16x32_bf16 v[44:47], v[32:35], v[104:107], v[44:47]
    v_mfma_f32_16x16x32_bf16 v[48:51], v[36:39], v[104:107], v[48:51]
    v_mfma_f32_16x16x32_bf16 v[52:55], v[28:31], v[108:111], v[52:55]
    v_mfma_f32_16x16x32_bf16 v[56:59], v[32:35], v[108:111], v[56:59]
    v_mfma_f32_16x16x32_bf16 v[60:63], v[36:39], v[108:111], v[60:63]
    ds_read_b64_tr_b16 v[28:29], v8 offset:21504
    ds_read_b64_tr_b16 v[30:31], v8 offset:21888
    ds_read_b64_tr_b16 v[32:33], v8 offset:21536
    ds_read_b64_tr_b16 v[34:35], v8 offset:21920
    ds_read_b64_tr_b16 v[36:37], v8 offset:21568
    ds_read_b64_tr_b16 v[38:39], v8 offset:21952
    global_load_dwordx4 v[160:163], v5, s[4:5] offset:768
    global_load_dwordx4 v[164:167], v7, s[4:5] offset:768
    s_waitcnt vmcnt(12) lgkmcnt(6)
    v_mfma_f32_16x16x32_bf16 v[40:43], v[16:19], v[112:115], v[40:43]
    v_mfma_f32_16x16x32_bf16 v[44:47], v[20:23], v[112:115], v[44:47]
    v_mfma_f32_16x16x32_bf16 v[48:51], v[24:27], v[112:115], v[48:51]
    v_mfma_f32_16x16x32_bf16 v[52:55], v[16:19], v[116:119], v[52:55]
    v_mfma_f32_16x16x32_bf16 v[56:59], v[20:23], v[116:119], v[56:59]
    v_mfma_f32_16x16x32_bf16 v[60:63], v[24:27], v[116:119], v[60:63]
    ds_read_b64_tr_b16 v[16:17], v8 offset:24576
    ds_read_b64_tr_b16 v[18:19], v8 offset:24960
    ds_read_b64_tr_b16 v[20:21], v8 offset:24608
    ds_read_b64_tr_b16 v[22:23], v8 offset:24992
    ds_read_b64_tr_b16 v[24:25], v8 offset:24640
    ds_read_b64_tr_b16 v[26:27], v8 offset:25024
    global_load_dwordx4 v[168:171], v5, s[4:5] offset:832
    global_load_dwordx4 v[172:175], v7, s[4:5] offset:832
    s_waitcnt vmcnt(12) lgkmcnt(6)
    v_mfma_f32_16x16x32_bf16 v[40:43], v[28:31], v[120:123], v[40:43]
    v_mfma_f32_16x16x32_bf16 v[44:47], v[32:35], v[120:123], v[44:47]
    v_mfma_f32_16x16x32_bf16 v[48:51], v[36:39], v[120:123], v[48:51]
    v_mfma_f32_16x16x32_bf16 v[52:55], v[28:31], v[124:127], v[52:55]
    v_mfma_f32_16x16x32_bf16 v[56:59], v[32:35], v[124:127], v[56:59]
    v_mfma_f32_16x16x32_bf16 v[60:63], v[36:39], v[124:127], v[60:63]
    ds_read_b64_tr_b16 v[28:29], v8 offset:27648
    ds_read_b64_tr_b16 v[30:31], v8 offset:28032
    ds_read_b64_tr_b16 v[32:33], v8 offset:27680
    ds_read_b64_tr_b16 v[34:35], v8 offset:28064
    ds_read_b64_tr_b16 v[36:37], v8 offset:27712
    ds_read_b64_tr_b16 v[38:39], v8 offset:28096
    global_load_dwordx4 v[176:179], v5, s[4:5] offset:896
    global_load_dwordx4 v[180:183], v7, s[4:5] offset:896
    s_waitcnt vmcnt(12) lgkmcnt(6)
    v_mfma_f32_16x16x32_bf16 v[40:43], v[16:19], v[128:131], v[40:43]
    v_mfma_f32_16x16x32_bf16 v[44:47], v[20:23], v[128:131], v[44:47]
    v_mfma_f32_16x16x32_bf16 v[48:51], v[24:27], v[128:131], v[48:51]
    v_mfma_f32_16x16x32_bf16 v[52:55], v[16:19], v[132:135], v[52:55]
    v_mfma_f32_16x16x32_bf16 v[56:59], v[20:23], v[132:135], v[56:59]
    v_mfma_f32_16x16x32_bf16 v[60:63], v[24:27], v[132:135], v[60:63]
    ds_read_b64_tr_b16 v[16:17], v8 offset:30720
    ds_read_b64_tr_b16 v[18:19], v8 offset:31104
    ds_read_b64_tr_b16 v[20:21], v8 offset:30752
    ds_read_b64_tr_b16 v[22:23], v8 offset:31136
    ds_read_b64_tr_b16 v[24:25], v8 offset:30784
    ds_read_b64_tr_b16 v[26:27], v8 offset:31168
    global_load_dwordx4 v[184:187], v5, s[4:5] offset:960
    global_load_dwordx4 v[188:191], v7, s[4:5] offset:960
    s_waitcnt vmcnt(12) lgkmcnt(6)
    v_mfma_f32_16x16x32_bf16 v[40:43], v[28:31], v[136:139], v[40:43]
    v_mfma_f32_16x16x32_bf16 v[44:47], v[32:35], v[136:139], v[44:47]
    v_mfma_f32_16x16x32_bf16 v[48:51], v[36:39], v[136:139], v[48:51]
    v_mfma_f32_16x16x32_bf16 v[52:55], v[28:31], v[140:143], v[52:55]
    v_mfma_f32_16x16x32_bf16 v[56:59], v[32:35], v[140:143], v[56:59]
    v_mfma_f32_16x16x32_bf16 v[60:63], v[36:39], v[140:143], v[60:63]
    ds_read_b64_tr_b16 v[28:29], v8 offset:33792
    ds_read_b64_tr_b16 v[30:31], v8 offset:34176
    ds_read_b64_tr_b16 v[32:33], v8 offset:33824
    ds_read_b64_tr_b16 v[34:35], v8 offset:34208
    ds_read_b64_tr_b16 v[36:37], v8 offset:33856
    ds_read_b64_tr_b16 v[38:39], v8 offset:34240
    global_load_dwordx4 v[192:195], v5, s[4:5] offset:1024
    global_load_dwordx4 v[196:199], v7, s[4:5] offset:1024
    s_waitcnt vmcnt(12) lgkmcnt(6)
    v_mfma_f32_16x16x32_bf16 v[40:43], v[16:19], v[144:147], v[40:43]
    v_mfma_f32_16x16x32_bf16 v[44:47], v[20:23], v[144:147], v[44:47]
    v_mfma_f32_16x16x32_bf16 v[48:51], v[24:27], v[144:147], v[48:51]
    v_mfma_f32_16x16x32_bf16 v[52:55], v[16:19], v[148:151], v[52:55]
    v_mfma_f32_16x16x32_bf16 v[56:59], v[20:23], v[148:151], v[56:59]
    v_mfma_f32_16x16x32_bf16 v[60:63], v[24:27], v[148:151], v[60:63]
    ds_read_b64_tr_b16 v[16:17], v8 offset:36864
    ds_read_b64_tr_b16 v[18:19], v8 offset:37248
    ds_read_b64_tr_b16 v[20:21], v8 offset:36896
    ds_read_b64_tr_b16 v[22:23], v8 offset:37280
    ds_read_b64_tr_b16 v[24:25], v8 offset:36928
    ds_read_b64_tr_b16 v[26:27], v8 offset:37312
    global_load_dwordx4 v[200:203], v5, s[4:5] offset:1088
    global_load_dwordx4 v[204:207], v7, s[4:5] offset:1088
    s_waitcnt vmcnt(12) lgkmcnt(6)
    v_mfma_f32_16x16x32_bf16 v[40:43], v[28:31], v[152:155], v[40:43]
    v_mfma_f32_16x16x32_bf16 v[44:47], v[32:35], v[152:155], v[44:47]
    v_mfma_f32_16x16x32_bf16 v[48:51], v[36:39], v[152:155], v[48:51]
    v_mfma_f32_16x16x32_bf16 v[52:55], v[28:31], v[156:159], v[52:55]
    v_mfma_f32_16x16x32_bf16 v[56:59], v[32:35], v[156:159], v[56:59]
    v_mfma_f32_16x16x32_bf16 v[60:63], v[36:39], v[156:159], v[60:63]
    ds_read_b64_tr_b16 v[28:29], v8 offset:39936
    ds_read_b64_tr_b16 v[30:31], v8 offset:40320
    ds_read_b64_tr_b16 v[32:33], v8 offset:39968
    ds_read_b64_tr_b16 v[34:35], v8 offset:40352
    ds_read_b64_tr_b16 v[36:37], v8 offset:40000
    ds_read_b64_tr_b16 v[38:39], v8 offset:40384
    s_waitcnt vmcnt(10) lgkmcnt(6)
    v_mfma_f32_16x16x32_bf16 v[40:43], v[16:19], v[160:163], v[40:43]
    v_mfma_f32_16x16x32_bf16 v[44:47], v[20:23], v[160:163], v[44:47]
    v_mfma_f32_16x16x32_bf16 v[48:51], v[24:27], v[160:163], v[48:51]
    v_mfma_f32_16x16x32_bf16 v[52:55], v[16:19], v[164:167], v[52:55]
    v_mfma_f32_16x16x32_bf16 v[56:59], v[20:23], v[164:167], v[56:59]
    v_mfma_f32_16x16x32_bf16 v[60:63], v[24:27], v[164:167], v[60:63]
    ds_read_b64_tr_b16 v[16:17], v8 offset:43008
    ds_read_b64_tr_b16 v[18:19], v8 offset:43392
    ds_read_b64_tr_b16 v[20:21], v8 offset:43040
    ds_read_b64_tr_b16 v[22:23], v8 offset:43424
    ds_read_b64_tr_b16 v[24:25], v8 offset:43072
    ds_read_b64_tr_b16 v[26:27], v8 offset:43456
    s_waitcnt vmcnt(8) lgkmcnt(6)
    v_mfma_f32_16x16x32_bf16 v[40:43], v[28:31], v[168:171], v[40:43]
    v_mfma_f32_16x16x32_bf16 v[44:47], v[32:35], v[168:171], v[44:47]
    v_mfma_f32_16x16x32_bf16 v[48:51], v[36:39], v[168:171], v[48:51]
    v_mfma_f32_16x16x32_bf16 v[52:55], v[28:31], v[172:175], v[52:55]
    v_mfma_f32_16x16x32_bf16 v[56:59], v[32:35], v[172:175], v[56:59]
    v_mfma_f32_16x16x32_bf16 v[60:63], v[36:39], v[172:175], v[60:63]
    ds_read_b64_tr_b16 v[28:29], v8 offset:46080
    ds_read_b64_tr_b16 v[30:31], v8 offset:46464
    ds_read_b64_tr_b16 v[32:33], v8 offset:46112
    ds_read_b64_tr_b16 v[34:35], v8 offset:46496
    ds_read_b64_tr_b16 v[36:37], v8 offset:46144
    ds_read_b64_tr_b16 v[38:39], v8 offset:46528
    s_waitcnt vmcnt(6) lgkmcnt(6)
    v_mfma_f32_16x16x32_bf16 v[40:43], v[16:19], v[176:179], v[40:43]
    v_mfma_f32_16x16x32_bf16 v[44:47], v[20:23], v[176:179], v[44:47]
    v_mfma_f32_16x16x32_bf16 v[48:51], v[24:27], v[176:179], v[48:51]
    v_mfma_f32_16x16x32_bf16 v[52:55], v[16:19], v[180:183], v[52:55]
    v_mfma_f32_16x16x32_bf16 v[56:59], v[20:23], v[180:183], v[56:59]
    v_mfma_f32_16x16x32_bf16 v[60:63], v[24:27], v[180:183], v[60:63]
    ds_read_b64_tr_b16 v[16:17], v8 offset:49152
    ds_read_b64_tr_b16 v[18:19], v8 offset:49536
    ds_read_b64_tr_b16 v[20:21], v8 offset:49184
    ds_read_b64_tr_b16 v[22:23], v8 offset:49568
    ds_read_b64_tr_b16 v[24:25], v8 offset:49216
    ds_read_b64_tr_b16 v[26:27], v8 offset:49600
    s_waitcnt vmcnt(4) lgkmcnt(6)
    v_mfma_f32_16x16x32_bf16 v[40:43], v[28:31], v[184:187], v[40:43]
    v_mfma_f32_16x16x32_bf16 v[44:47], v[32:35], v[184:187], v[44:47]
    v_mfma_f32_16x16x32_bf16 v[48:51], v[36:39], v[184:187], v[48:51]
    v_mfma_f32_16x16x32_bf16 v[52:55], v[28:31], v[188:191], v[52:55]
    v_mfma_f32_16x16x32_bf16 v[56:59], v[32:35], v[188:191], v[56:59]
    v_mfma_f32_16x16x32_bf16 v[60:63], v[36:39], v[188:191], v[60:63]
    ds_read_b64_tr_b16 v[28:29], v8 offset:52224
    ds_read_b64_tr_b16 v[30:31], v8 offset:52608
    ds_read_b64_tr_b16 v[32:33], v8 offset:52256
    ds_read_b64_tr_b16 v[34:35], v8 offset:52640
    ds_read_b64_tr_b16 v[36:37], v8 offset:52288
    ds_read_b64_tr_b16 v[38:39], v8 offset:52672
    s_waitcnt vmcnt(2) lgkmcnt(6)
    v_mfma_f32_16x16x32_bf16 v[40:43], v[16:19], v[192:195], v[40:43]
    v_mfma_f32_16x16x32_bf16 v[44:47], v[20:23], v[192:195], v[44:47]
    v_mfma_f32_16x16x32_bf16 v[48:51], v[24:27], v[192:195], v[48:51]
    v_mfma_f32_16x16x32_bf16 v[52:55], v[16:19], v[196:199], v[52:55]
    v_mfma_f32_16x16x32_bf16 v[56:59], v[20:23], v[196:199], v[56:59]
    v_mfma_f32_16x16x32_bf16 v[60:63], v[24:27], v[196:199], v[60:63]
    s_waitcnt vmcnt(0) lgkmcnt(0)
    v_mfma_f32_16x16x32_bf16 v[40:43], v[28:31], v[200:203], v[40:43]
    v_mfma_f32_16x16x32_bf16 v[44:47], v[32:35], v[200:203], v[44:47]
    v_mfma_f32_16x16x32_bf16 v[48:51], v[36:39], v[200:203], v[48:51]
    v_mfma_f32_16x16x32_bf16 v[52:55], v[28:31], v[204:207], v[52:55]
    v_mfma_f32_16x16x32_bf16 v[56:59], v[32:35], v[204:207], v[56:59]
    v_mfma_f32_16x16x32_bf16 v[60:63], v[36:39], v[204:207], v[60:63]
    s_nop 15
    v_max3_f32 v208, abs(v40), abs(v41), abs(v42)
    v_max3_f32 v208, v208, abs(v43), abs(v52)
    v_max3_f32 v208, v208, abs(v53), abs(v54)
    v_max_f32 v208, v208, abs(v55)
    v_max3_f32 v209, abs(v44), abs(v45), abs(v56)
    v_max_f32 v209, v209, abs(v57)
    v_cmp_eq_u32 vcc, 0, v2
    s_nop 1
    v_cndmask_b32 v209, 0, v209, vcc
    v_max_f32 v208, v208, v209
    s_nop 1
    v_max_f32_dpp v208, v208, v208 row_ror:1 row_mask:0xf bank_mask:0xf
    s_nop 1
    v_max_f32_dpp v208, v208, v208 row_ror:2 row_mask:0xf bank_mask:0xf
    s_nop 1
    v_max_f32_dpp v208, v208, v208 row_ror:4 row_mask:0xf bank_mask:0xf
    s_nop 1
    v_max_f32_dpp v208, v208, v208 row_ror:8 row_mask:0xf bank_mask:0xf
    s_nop 1
    v_readlane_b32 s26, v208, 0
    v_readlane_b32 s27, v208, 16
    v_readlane_b32 s28, v208, 32
    v_readlane_b32 s29, v208, 48
    s_nop 1
    v_mov_b32 v208, s26
    v_max_f32 v208, s27, v208
    v_max_f32 v208, s28, v208
    v_max_f32 v208, s29, v208
    s_add_u32 s26, s6, 14483456
    s_addc_u32 s27, s7, 0
    v_mov_b32 v209, s13
    v_add_u32 v209, v4, v209
    v_lshlrev_b32 v209, 2, v209
    global_store_dword v209, v208, s[26:27]
    v_lshl_add_u32 v11, v14, 10, v13
    v_lshrrev_b32 v12, 1, v2
    v_lshl_add_u32 v11, v12, 9, v11
    v_lshl_add_u32 v11, v3, 4, v11
    v_and_b32 v12, 1, v2
    v_lshl_add_u32 v11, v12, 3, v11
    v_cvt_pk_bf16_f32 v40, v40, v41
    v_cvt_pk_bf16_f32 v41, v42, v43
    global_store_dwordx2 v11, v[40:41], s[16:17] offset:0
    v_cvt_pk_bf16_f32 v52, v52, v53
    v_cvt_pk_bf16_f32 v53, v54, v55
    global_store_dwordx2 v11, v[52:53], s[16:17] offset:256
    v_cmp_eq_u32 vcc, 0, v2
    s_and_saveexec_b64 s[20:21], vcc
    v_lshl_add_u32 v11, v14, 8, v13
    v_lshl_add_u32 v11, v3, 3, v11
    v_add_u32 v11, 32768, v11
    s_add_u32 s18, s6, 4882432
    s_addc_u32 s19, s7, 0
    v_lshl_add_u32 v10, v4, 5, v3
    v_add_u32 v10, s12, v10
    v_lshlrev_b32 v10, 2, v10
    v_cvt_pk_bf16_f32 v44, v44, v45
    v_mov_b32 v45, 0x3f80
    global_store_dwordx2 v11, v[44:45], s[16:17] offset:0
    v_bfe_u32 v12, v46, 16, 1
    v_add3_u32 v46, v46, v12, s90
    v_and_b32 v46, 0xffff0000, v46
    v_mul_f32 v47, 3216550459, v46
    v_exp_f32 v47, v47
    s_nop 0
    v_add_f32 v47, 1.0, v47
    v_rcp_f32 v47, v47
    s_nop 0
    v_bfe_u32 v12, v47, 16, 1
    v_add3_u32 v47, v47, v12, s90
    v_and_b32 v47, 0xffff0000, v47
    global_store_dword v10, v47, s[18:19] offset:0
    v_cvt_pk_bf16_f32 v56, v56, v57
    v_mov_b32 v57, 0x3f80
    global_store_dwordx2 v11, v[56:57], s[16:17] offset:128
    v_bfe_u32 v12, v58, 16, 1
    v_add3_u32 v58, v58, v12, s90
    v_and_b32 v58, 0xffff0000, v58
    v_mul_f32 v59, 3216550459, v58
    v_exp_f32 v59, v59
    s_nop 0
    v_add_f32 v59, 1.0, v59
    v_rcp_f32 v59, v59
    s_nop 0
    v_bfe_u32 v12, v59, 16, 1
    v_add3_u32 v59, v59, v12, s90
    v_and_b32 v59, 0xffff0000, v59
    global_store_dword v10, v59, s[18:19] offset:64
    s_endpgm
K1_KV_V:
    ds_read_b64_tr_b16 v[16:17], v8 offset:0
    ds_read_b64_tr_b16 v[18:19], v8 offset:384
    ds_read_b64_tr_b16 v[20:21], v8 offset:32
    ds_read_b64_tr_b16 v[22:23], v8 offset:416
    ds_read_b64_tr_b16 v[24:25], v8 offset:64
    ds_read_b64_tr_b16 v[26:27], v8 offset:448
    ds_read_b64_tr_b16 v[28:29], v8 offset:3072
    ds_read_b64_tr_b16 v[30:31], v8 offset:3456
    ds_read_b64_tr_b16 v[32:33], v8 offset:3104
    ds_read_b64_tr_b16 v[34:35], v8 offset:3488
    ds_read_b64_tr_b16 v[36:37], v8 offset:3136
    ds_read_b64_tr_b16 v[38:39], v8 offset:3520
    global_load_dwordx4 v[112:115], v5, s[4:5] offset:384
    global_load_dwordx4 v[116:119], v7, s[4:5] offset:384
    s_waitcnt vmcnt(12) lgkmcnt(6)
    v_mfma_f32_16x16x32_bf16 v[40:43], v[64:67], v[16:19], 0
    v_mfma_f32_16x16x32_bf16 v[44:47], v[64:67], v[20:23], 0
    v_mfma_f32_16x16x32_bf16 v[48:51], v[64:67], v[24:27], 0
    v_mfma_f32_16x16x32_bf16 v[52:55], v[68:71], v[16:19], 0
    v_mfma_f32_16x16x32_bf16 v[56:59], v[68:71], v[20:23], 0
    v_mfma_f32_16x16x32_bf16 v[60:63], v[68:71], v[24:27], 0
    ds_read_b64_tr_b16 v[16:17], v8 offset:6144
    ds_read_b64_tr_b16 v[18:19], v8 offset:6528
    ds_read_b64_tr_b16 v[20:21], v8 offset:6176
    ds_read_b64_tr_b16 v[22:23], v8 offset:6560
    ds_read_b64_tr_b16 v[24:25], v8 offset:6208
    ds_read_b64_tr_b16 v[26:27], v8 offset:6592
    global_load_dwordx4 v[120:123], v5, s[4:5] offset:448
    global_load_dwordx4 v[124:127], v7, s[4:5] offset:448
    s_waitcnt vmcnt(12) lgkmcnt(6)
    v_mfma_f32_16x16x32_bf16 v[40:43], v[72:75], v[28:31], v[40:43]
    v_mfma_f32_16x16x32_bf16 v[44:47], v[72:75], v[32:35], v[44:47]
    v_mfma_f32_16x16x32_bf16 v[48:51], v[72:75], v[36:39], v[48:51]
    v_mfma_f32_16x16x32_bf16 v[52:55], v[76:79], v[28:31], v[52:55]
    v_mfma_f32_16x16x32_bf16 v[56:59], v[76:79], v[32:35], v[56:59]
    v_mfma_f32_16x16x32_bf16 v[60:63], v[76:79], v[36:39], v[60:63]
    ds_read_b64_tr_b16 v[28:29], v8 offset:9216
    ds_read_b64_tr_b16 v[30:31], v8 offset:9600
    ds_read_b64_tr_b16 v[32:33], v8 offset:9248
    ds_read_b64_tr_b16 v[34:35], v8 offset:9632
    ds_read_b64_tr_b16 v[36:37], v8 offset:9280
    ds_read_b64_tr_b16 v[38:39], v8 offset:9664
    global_load_dwordx4 v[128:131], v5, s[4:5] offset:512
    global_load_dwordx4 v[132:135], v7, s[4:5] offset:512
    s_waitcnt vmcnt(12) lgkmcnt(6)
    v_mfma_f32_16x16x32_bf16 v[40:43], v[80:83], v[16:19], v[40:43]
    v_mfma_f32_16x16x32_bf16 v[44:47], v[80:83], v[20:23], v[44:47]
    v_mfma_f32_16x16x32_bf16 v[48:51], v[80:83], v[24:27], v[48:51]
    v_mfma_f32_16x16x32_bf16 v[52:55], v[84:87], v[16:19], v[52:55]
    v_mfma_f32_16x16x32_bf16 v[56:59], v[84:87], v[20:23], v[56:59]
    v_mfma_f32_16x16x32_bf16 v[60:63], v[84:87], v[24:27], v[60:63]
    ds_read_b64_tr_b16 v[16:17], v8 offset:12288
    ds_read_b64_tr_b16 v[18:19], v8 offset:12672
    ds_read_b64_tr_b16 v[20:21], v8 offset:12320
    ds_read_b64_tr_b16 v[22:23], v8 offset:12704
    ds_read_b64_tr_b16 v[24:25], v8 offset:12352
    ds_read_b64_tr_b16 v[26:27], v8 offset:12736
    global_load_dwordx4 v[136:139], v5, s[4:5] offset:576
    global_load_dwordx4 v[140:143], v7, s[4:5] offset:576
    s_waitcnt vmcnt(12) lgkmcnt(6)
    v_mfma_f32_16x16x32_bf16 v[40:43], v[88:91], v[28:31], v[40:43]
    v_mfma_f32_16x16x32_bf16 v[44:47], v[88:91], v[32:35], v[44:47]
    v_mfma_f32_16x16x32_bf16 v[48:51], v[88:91], v[36:39], v[48:51]
    v_mfma_f32_16x16x32_bf16 v[52:55], v[92:95], v[28:31], v[52:55]
    v_mfma_f32_16x16x32_bf16 v[56:59], v[92:95], v[32:35], v[56:59]
    v_mfma_f32_16x16x32_bf16 v[60:63], v[92:95], v[36:39], v[60:63]
    ds_read_b64_tr_b16 v[28:29], v8 offset:15360
    ds_read_b64_tr_b16 v[30:31], v8 offset:15744
    ds_read_b64_tr_b16 v[32:33], v8 offset:15392
    ds_read_b64_tr_b16 v[34:35], v8 offset:15776
    ds_read_b64_tr_b16 v[36:37], v8 offset:15424
    ds_read_b64_tr_b16 v[38:39], v8 offset:15808
    global_load_dwordx4 v[144:147], v5, s[4:5] offset:640
    global_load_dwordx4 v[148:151], v7, s[4:5] offset:640
    s_waitcnt vmcnt(12) lgkmcnt(6)
    v_mfma_f32_16x16x32_bf16 v[40:43], v[96:99], v[16:19], v[40:43]
    v_mfma_f32_16x16x32_bf16 v[44:47], v[96:99], v[20:23], v[44:47]
    v_mfma_f32_16x16x32_bf16 v[48:51], v[96:99], v[24:27], v[48:51]
    v_mfma_f32_16x16x32_bf16 v[52:55], v[100:103], v[16:19], v[52:55]
    v_mfma_f32_16x16x32_bf16 v[56:59], v[100:103], v[20:23], v[56:59]
    v_mfma_f32_16x16x32_bf16 v[60:63], v[100:103], v[24:27], v[60:63]
    ds_read_b64_tr_b16 v[16:17], v8 offset:18432
    ds_read_b64_tr_b16 v[18:19], v8 offset:18816
    ds_read_b64_tr_b16 v[20:21], v8 offset:18464
    ds_read_b64_tr_b16 v[22:23], v8 offset:18848
    ds_read_b64_tr_b16 v[24:25], v8 offset:18496
    ds_read_b64_tr_b16 v[26:27], v8 offset:18880
    global_load_dwordx4 v[152:155], v5, s[4:5] offset:704
    global_load_dwordx4 v[156:159], v7, s[4:5] offset:704
    s_waitcnt vmcnt(12) lgkmcnt(6)
    v_mfma_f32_16x16x32_bf16 v[40:43], v[104:107], v[28:31], v[40:43]
    v_mfma_f32_16x16x32_bf16 v[44:47], v[104:107], v[32:35], v[44:47]
    v_mfma_f32_16x16x32_bf16 v[48:51], v[104:107], v[36:39], v[48:51]
    v_mfma_f32_16x16x32_bf16 v[52:55], v[108:111], v[28:31], v[52:55]
    v_mfma_f32_16x16x32_bf16 v[56:59], v[108:111], v[32:35], v[56:59]
    v_mfma_f32_16x16x32_bf16 v[60:63], v[108:111], v[36:39], v[60:63]
    ds_read_b64_tr_b16 v[28:29], v8 offset:21504
    ds_read_b64_tr_b16 v[30:31], v8 offset:21888
    ds_read_b64_tr_b16 v[32:33], v8 offset:21536
    ds_read_b64_tr_b16 v[34:35], v8 offset:21920
    ds_read_b64_tr_b16 v[36:37], v8 offset:21568
    ds_read_b64_tr_b16 v[38:39], v8 offset:21952
    global_load_dwordx4 v[160:163], v5, s[4:5] offset:768
    global_load_dwordx4 v[164:167], v7, s[4:5] offset:768
    s_waitcnt vmcnt(12) lgkmcnt(6)
    v_mfma_f32_16x16x32_bf16 v[40:43], v[112:115], v[16:19], v[40:43]
    v_mfma_f32_16x16x32_bf16 v[44:47], v[112:115], v[20:23], v[44:47]
    v_mfma_f32_16x16x32_bf16 v[48:51], v[112:115], v[24:27], v[48:51]
    v_mfma_f32_16x16x32_bf16 v[52:55], v[116:119], v[16:19], v[52:55]
    v_mfma_f32_16x16x32_bf16 v[56:59], v[116:119], v[20:23], v[56:59]
    v_mfma_f32_16x16x32_bf16 v[60:63], v[116:119], v[24:27], v[60:63]
    ds_read_b64_tr_b16 v[16:17], v8 offset:24576
    ds_read_b64_tr_b16 v[18:19], v8 offset:24960
    ds_read_b64_tr_b16 v[20:21], v8 offset:24608
    ds_read_b64_tr_b16 v[22:23], v8 offset:24992
    ds_read_b64_tr_b16 v[24:25], v8 offset:24640
    ds_read_b64_tr_b16 v[26:27], v8 offset:25024
    global_load_dwordx4 v[168:171], v5, s[4:5] offset:832
    global_load_dwordx4 v[172:175], v7, s[4:5] offset:832
    s_waitcnt vmcnt(12) lgkmcnt(6)
    v_mfma_f32_16x16x32_bf16 v[40:43], v[120:123], v[28:31], v[40:43]
    v_mfma_f32_16x16x32_bf16 v[44:47], v[120:123], v[32:35], v[44:47]
    v_mfma_f32_16x16x32_bf16 v[48:51], v[120:123], v[36:39], v[48:51]
    v_mfma_f32_16x16x32_bf16 v[52:55], v[124:127], v[28:31], v[52:55]
    v_mfma_f32_16x16x32_bf16 v[56:59], v[124:127], v[32:35], v[56:59]
    v_mfma_f32_16x16x32_bf16 v[60:63], v[124:127], v[36:39], v[60:63]
    ds_read_b64_tr_b16 v[28:29], v8 offset:27648
    ds_read_b64_tr_b16 v[30:31], v8 offset:28032
    ds_read_b64_tr_b16 v[32:33], v8 offset:27680
    ds_read_b64_tr_b16 v[34:35], v8 offset:28064
    ds_read_b64_tr_b16 v[36:37], v8 offset:27712
    ds_read_b64_tr_b16 v[38:39], v8 offset:28096
    global_load_dwordx4 v[176:179], v5, s[4:5] offset:896
    global_load_dwordx4 v[180:183], v7, s[4:5] offset:896
    s_waitcnt vmcnt(12) lgkmcnt(6)
    v_mfma_f32_16x16x32_bf16 v[40:43], v[128:131], v[16:19], v[40:43]
    v_mfma_f32_16x16x32_bf16 v[44:47], v[128:131], v[20:23], v[44:47]
    v_mfma_f32_16x16x32_bf16 v[48:51], v[128:131], v[24:27], v[48:51]
    v_mfma_f32_16x16x32_bf16 v[52:55], v[132:135], v[16:19], v[52:55]
    v_mfma_f32_16x16x32_bf16 v[56:59], v[132:135], v[20:23], v[56:59]
    v_mfma_f32_16x16x32_bf16 v[60:63], v[132:135], v[24:27], v[60:63]
    ds_read_b64_tr_b16 v[16:17], v8 offset:30720
    ds_read_b64_tr_b16 v[18:19], v8 offset:31104
    ds_read_b64_tr_b16 v[20:21], v8 offset:30752
    ds_read_b64_tr_b16 v[22:23], v8 offset:31136
    ds_read_b64_tr_b16 v[24:25], v8 offset:30784
    ds_read_b64_tr_b16 v[26:27], v8 offset:31168
    global_load_dwordx4 v[184:187], v5, s[4:5] offset:960
    global_load_dwordx4 v[188:191], v7, s[4:5] offset:960
    s_waitcnt vmcnt(12) lgkmcnt(6)
    v_mfma_f32_16x16x32_bf16 v[40:43], v[136:139], v[28:31], v[40:43]
    v_mfma_f32_16x16x32_bf16 v[44:47], v[136:139], v[32:35], v[44:47]
    v_mfma_f32_16x16x32_bf16 v[48:51], v[136:139], v[36:39], v[48:51]
    v_mfma_f32_16x16x32_bf16 v[52:55], v[140:143], v[28:31], v[52:55]
    v_mfma_f32_16x16x32_bf16 v[56:59], v[140:143], v[32:35], v[56:59]
    v_mfma_f32_16x16x32_bf16 v[60:63], v[140:143], v[36:39], v[60:63]
    ds_read_b64_tr_b16 v[28:29], v8 offset:33792
    ds_read_b64_tr_b16 v[30:31], v8 offset:34176
    ds_read_b64_tr_b16 v[32:33], v8 offset:33824
    ds_read_b64_tr_b16 v[34:35], v8 offset:34208
    ds_read_b64_tr_b16 v[36:37], v8 offset:33856
    ds_read_b64_tr_b16 v[38:39], v8 offset:34240
    global_load_dwordx4 v[192:195], v5, s[4:5] offset:1024
    global_load_dwordx4 v[196:199], v7, s[4:5] offset:1024
    s_waitcnt vmcnt(12) lgkmcnt(6)
    v_mfma_f32_16x16x32_bf16 v[40:43], v[144:147], v[16:19], v[40:43]
    v_mfma_f32_16x16x32_bf16 v[44:47], v[144:147], v[20:23], v[44:47]
    v_mfma_f32_16x16x32_bf16 v[48:51], v[144:147], v[24:27], v[48:51]
    v_mfma_f32_16x16x32_bf16 v[52:55], v[148:151], v[16:19], v[52:55]
    v_mfma_f32_16x16x32_bf16 v[56:59], v[148:151], v[20:23], v[56:59]
    v_mfma_f32_16x16x32_bf16 v[60:63], v[148:151], v[24:27], v[60:63]
    ds_read_b64_tr_b16 v[16:17], v8 offset:36864
    ds_read_b64_tr_b16 v[18:19], v8 offset:37248
    ds_read_b64_tr_b16 v[20:21], v8 offset:36896
    ds_read_b64_tr_b16 v[22:23], v8 offset:37280
    ds_read_b64_tr_b16 v[24:25], v8 offset:36928
    ds_read_b64_tr_b16 v[26:27], v8 offset:37312
    global_load_dwordx4 v[200:203], v5, s[4:5] offset:1088
    global_load_dwordx4 v[204:207], v7, s[4:5] offset:1088
    s_waitcnt vmcnt(12) lgkmcnt(6)
    v_mfma_f32_16x16x32_bf16 v[40:43], v[152:155], v[28:31], v[40:43]
    v_mfma_f32_16x16x32_bf16 v[44:47], v[152:155], v[32:35], v[44:47]
    v_mfma_f32_16x16x32_bf16 v[48:51], v[152:155], v[36:39], v[48:51]
    v_mfma_f32_16x16x32_bf16 v[52:55], v[156:159], v[28:31], v[52:55]
    v_mfma_f32_16x16x32_bf16 v[56:59], v[156:159], v[32:35], v[56:59]
    v_mfma_f32_16x16x32_bf16 v[60:63], v[156:159], v[36:39], v[60:63]
    ds_read_b64_tr_b16 v[28:29], v8 offset:39936
    ds_read_b64_tr_b16 v[30:31], v8 offset:40320
    ds_read_b64_tr_b16 v[32:33], v8 offset:39968
    ds_read_b64_tr_b16 v[34:35], v8 offset:40352
    ds_read_b64_tr_b16 v[36:37], v8 offset:40000
    ds_read_b64_tr_b16 v[38:39], v8 offset:40384
    s_waitcnt vmcnt(10) lgkmcnt(6)
    v_mfma_f32_16x16x32_bf16 v[40:43], v[160:163], v[16:19], v[40:43]
    v_mfma_f32_16x16x32_bf16 v[44:47], v[160:163], v[20:23], v[44:47]
    v_mfma_f32_16x16x32_bf16 v[48:51], v[160:163], v[24:27], v[48:51]
    v_mfma_f32_16x16x32_bf16 v[52:55], v[164:167], v[16:19], v[52:55]
    v_mfma_f32_16x16x32_bf16 v[56:59], v[164:167], v[20:23], v[56:59]
    v_mfma_f32_16x16x32_bf16 v[60:63], v[164:167], v[24:27], v[60:63]
    ds_read_b64_tr_b16 v[16:17], v8 offset:43008
    ds_read_b64_tr_b16 v[18:19], v8 offset:43392
    ds_read_b64_tr_b16 v[20:21], v8 offset:43040
    ds_read_b64_tr_b16 v[22:23], v8 offset:43424
    ds_read_b64_tr_b16 v[24:25], v8 offset:43072
    ds_read_b64_tr_b16 v[26:27], v8 offset:43456
    s_waitcnt vmcnt(8) lgkmcnt(6)
    v_mfma_f32_16x16x32_bf16 v[40:43], v[168:171], v[28:31], v[40:43]
    v_mfma_f32_16x16x32_bf16 v[44:47], v[168:171], v[32:35], v[44:47]
    v_mfma_f32_16x16x32_bf16 v[48:51], v[168:171], v[36:39], v[48:51]
    v_mfma_f32_16x16x32_bf16 v[52:55], v[172:175], v[28:31], v[52:55]
    v_mfma_f32_16x16x32_bf16 v[56:59], v[172:175], v[32:35], v[56:59]
    v_mfma_f32_16x16x32_bf16 v[60:63], v[172:175], v[36:39], v[60:63]
    ds_read_b64_tr_b16 v[28:29], v8 offset:46080
    ds_read_b64_tr_b16 v[30:31], v8 offset:46464
    ds_read_b64_tr_b16 v[32:33], v8 offset:46112
    ds_read_b64_tr_b16 v[34:35], v8 offset:46496
    ds_read_b64_tr_b16 v[36:37], v8 offset:46144
    ds_read_b64_tr_b16 v[38:39], v8 offset:46528
    s_waitcnt vmcnt(6) lgkmcnt(6)
    v_mfma_f32_16x16x32_bf16 v[40:43], v[176:179], v[16:19], v[40:43]
    v_mfma_f32_16x16x32_bf16 v[44:47], v[176:179], v[20:23], v[44:47]
    v_mfma_f32_16x16x32_bf16 v[48:51], v[176:179], v[24:27], v[48:51]
    v_mfma_f32_16x16x32_bf16 v[52:55], v[180:183], v[16:19], v[52:55]
    v_mfma_f32_16x16x32_bf16 v[56:59], v[180:183], v[20:23], v[56:59]
    v_mfma_f32_16x16x32_bf16 v[60:63], v[180:183], v[24:27], v[60:63]
    ds_read_b64_tr_b16 v[16:17], v8 offset:49152
    ds_read_b64_tr_b16 v[18:19], v8 offset:49536
    ds_read_b64_tr_b16 v[20:21], v8 offset:49184
    ds_read_b64_tr_b16 v[22:23], v8 offset:49568
    ds_read_b64_tr_b16 v[24:25], v8 offset:49216
    ds_read_b64_tr_b16 v[26:27], v8 offset:49600
    s_waitcnt vmcnt(4) lgkmcnt(6)
    v_mfma_f32_16x16x32_bf16 v[40:43], v[184:187], v[28:31], v[40:43]
    v_mfma_f32_16x16x32_bf16 v[44:47], v[184:187], v[32:35], v[44:47]
    v_mfma_f32_16x16x32_bf16 v[48:51], v[184:187], v[36:39], v[48:51]
    v_mfma_f32_16x16x32_bf16 v[52:55], v[188:191], v[28:31], v[52:55]
    v_mfma_f32_16x16x32_bf16 v[56:59], v[188:191], v[32:35], v[56:59]
    v_mfma_f32_16x16x32_bf16 v[60:63], v[188:191], v[36:39], v[60:63]
    ds_read_b64_tr_b16 v[28:29], v8 offset:52224
    ds_read_b64_tr_b16 v[30:31], v8 offset:52608
    ds_read_b64_tr_b16 v[32:33], v8 offset:52256
    ds_read_b64_tr_b16 v[34:35], v8 offset:52640
    ds_read_b64_tr_b16 v[36:37], v8 offset:52288
    ds_read_b64_tr_b16 v[38:39], v8 offset:52672
    s_waitcnt vmcnt(2) lgkmcnt(6)
    v_mfma_f32_16x16x32_bf16 v[40:43], v[192:195], v[16:19], v[40:43]
    v_mfma_f32_16x16x32_bf16 v[44:47], v[192:195], v[20:23], v[44:47]
    v_mfma_f32_16x16x32_bf16 v[48:51], v[192:195], v[24:27], v[48:51]
    v_mfma_f32_16x16x32_bf16 v[52:55], v[196:199], v[16:19], v[52:55]
    v_mfma_f32_16x16x32_bf16 v[56:59], v[196:199], v[20:23], v[56:59]
    v_mfma_f32_16x16x32_bf16 v[60:63], v[196:199], v[24:27], v[60:63]
    s_waitcnt vmcnt(0) lgkmcnt(0)
    v_mfma_f32_16x16x32_bf16 v[40:43], v[200:203], v[28:31], v[40:43]
    v_mfma_f32_16x16x32_bf16 v[44:47], v[200:203], v[32:35], v[44:47]
    v_mfma_f32_16x16x32_bf16 v[48:51], v[200:203], v[36:39], v[48:51]
    v_mfma_f32_16x16x32_bf16 v[52:55], v[204:207], v[28:31], v[52:55]
    v_mfma_f32_16x16x32_bf16 v[56:59], v[204:207], v[32:35], v[56:59]
    v_mfma_f32_16x16x32_bf16 v[60:63], v[204:207], v[36:39], v[60:63]
    s_nop 15
    v_mul_lo_u32 v11, v14, s91
    v_add_u32 v11, v13, v11
    v_and_b32 v12, 1, v2
    v_mul_u32_u24 v12, 18, v12
    v_add_u32 v12, v3, v12
    v_lshl_add_u32 v11, v12, 4, v11
    v_lshrrev_b32 v12, 1, v2
    v_lshl_add_u32 v11, v12, 3, v11
    v_add_u32 v11, 40960, v11
    v_cvt_pk_bf16_f32 v40, v40, v41
    v_cvt_pk_bf16_f32 v41, v42, v43
    global_store_dwordx2 v11, v[40:41], s[16:17] offset:0
    v_cvt_pk_bf16_f32 v52, v52, v53
    v_cvt_pk_bf16_f32 v53, v54, v55
    global_store_dwordx2 v11, v[52:53], s[16:17] offset:576
    v_cmp_gt_u32 vcc, 2, v3
    s_and_saveexec_b64 s[20:21], vcc
    v_cvt_pk_bf16_f32 v44, v44, v45
    v_cvt_pk_bf16_f32 v45, v46, v47
    global_store_dwordx2 v11, v[44:45], s[16:17] offset:256
    v_cvt_pk_bf16_f32 v56, v56, v57
    v_cvt_pk_bf16_f32 v57, v58, v59
    global_store_dwordx2 v11, v[56:57], s[16:17] offset:832
    s_endpgm
K1_KGEN:
    s_load_dwordx2 s[8:9], s[0:1], 8
    s_load_dwordx2 s[10:11], s[0:1], 16
    s_load_dwordx2 s[12:13], s[0:1], 24
    s_load_dwordx2 s[14:15], s[0:1], 32
    s_load_dwordx2 s[16:17], s[0:1], 40
    v_and_b32 v1, 63, v0
    v_lshrrev_b32 v2, 6, v0
    s_nop 1
    v_readfirstlane_b32 s89, v2
    v_and_b32 v20, 1, v2
    v_lshl_add_u32 v20, v20, 6, v1
    v_lshlrev_b32 v21, 1, v20
    s_mul_i32 s30, s2, 2
    s_lshl_b32 s3, s30, 8
    v_add_u32 v21, s3, v21
    s_lshl_b32 s3, s30, 1
    v_mov_b32 v22, s3
    s_waitcnt lgkmcnt(0)
    global_load_ushort v120, v22, s[16:17] offset:0
    global_load_ushort v121, v21, s[8:9] offset:0
    global_load_ushort v122, v21, s[10:11] offset:0
    global_load_ushort v123, v21, s[12:13] offset:0
    global_load_ushort v124, v21, s[14:15] offset:0
    global_load_ushort v125, v22, s[16:17] offset:2
    global_load_ushort v126, v21, s[8:9] offset:256
    global_load_ushort v127, v21, s[10:11] offset:256
    global_load_ushort v128, v21, s[12:13] offset:256
    global_load_ushort v129, v21, s[14:15] offset:256
    v_lshlrev_b32 v119, 2, v20
    v_lshlrev_b32 v23, 2, v20
    s_mov_b32 s20, 1069066811
    s_mov_b32 s21, 1042479491
    s_lshr_b32 s22, s89, 1
    s_add_u32 s31, s30, 0
    s_waitcnt vmcnt(0)
    v_lshlrev_b32 v4, 16, v120
    v_lshlrev_b32 v5, 16, v121
    v_lshlrev_b32 v6, 16, v122
    v_lshlrev_b32 v7, 16, v123
    v_lshlrev_b32 v8, 16, v124
    v_mov_b32 v23, v119
    v_mul_f32 v4, s20, v4
    v_mul_f32 v5, s20, v5
    v_exp_f32 v4, v4
    v_exp_f32 v5, v5
    s_nop 0
    v_bfe_u32 v20, v4, 16, 1
    v_add3_u32 v4, v4, v20, s90
    v_and_b32 v4, 0xffff0000, v4
    v_bfe_u32 v20, v5, 16, 1
    v_add3_u32 v5, v5, v20, s90
    v_and_b32 v5, 0xffff0000, v5
    v_mul_f32 v5, v4, v5
    v_mul_f32 v6, v4, v6
    v_mul_f32 v5, s20, v5
    v_mul_f32 v6, s21, v6
    v_mul_f32 v7, v4, v7
    v_mul_f32 v8, v4, v8
    v_add_f32 v7, v7, v7
    v_add_f32 v8, v8, v8
    v_mul_f32 v20, 3254779904, v5
    v_mul_f32 v21, 1107296256, v6
    v_exp_f32 v20, v20
    v_fract_f32 v21, v21
    v_cos_f32 v10, v21
    v_sin_f32 v11, v21
    s_nop 0
    v_mul_f32 v10, v20, v10
    v_mul_f32 v11, -v20, v11
    s_cmp_eq_u32 s22, 0
    s_cbranch_scc0 K1_KG_P1_0
    v_mul_f32 v20, 3212836864, v5
    v_mul_f32 v21, 1065353216, v6
    v_exp_f32 v20, v20
    v_fract_f32 v21, v21
    v_cos_f32 v12, v21
    v_sin_f32 v13, v21
    s_nop 0
    v_mul_f32 v12, v20, v12
    v_mul_f32 v13, v20, v13
    v_mov_b32 v14, v7
    v_sub_f32 v15, 0, v8
    v_mov_b32 v16, v12
    v_mov_b32 v17, v13
    v_mov_b32 v9, v23
    v_add_u32 v18, 33792, v23
    v_cvt_pk_bf16_f32 v24, v14, v15
    ds_write_b32 v9, v24 offset:0
    v_cvt_pk_bf16_f32 v25, v16, v17
    ds_write_b32 v18, v25 offset:0
    v_pk_mul_f32 v[26:27], v[14:15], v[10:11] op_sel_hi:[1,0]
    v_pk_fma_f32 v[14:15], v[14:15], v[10:11], v[26:27] op_sel:[1,1,0] op_sel_hi:[0,1,1] neg_lo:[1,0,0]
    v_pk_mul_f32 v[28:29], v[16:17], v[12:13] op_sel_hi:[1,0]
    v_pk_fma_f32 v[16:17], v[16:17], v[12:13], v[28:29] op_sel:[1,1,0] op_sel_hi:[0,1,1] neg_lo:[1,0,0]
    v_cvt_pk_bf16_f32 v24, v14, v15
    ds_write_b32 v9, v24 offset:528
    v_cvt_pk_bf16_f32 v25, v16, v17
    ds_write_b32 v18, v25 offset:528
    v_pk_mul_f32 v[26:27], v[14:15], v[10:11] op_sel_hi:[1,0]
    v_pk_fma_f32 v[14:15], v[14:15], v[10:11], v[26:27] op_sel:[1,1,0] op_sel_hi:[0,1,1] neg_lo:[1,0,0]
    v_pk_mul_f32 v[28:29], v[16:17], v[12:13] op_sel_hi:[1,0]
    v_pk_fma_f32 v[16:17], v[16:17], v[12:13], v[28:29] op_sel:[1,1,0] op_sel_hi:[0,1,1] neg_lo:[1,0,0]
    v_cvt_pk_bf16_f32 v24, v14, v15
    ds_write_b32 v9, v24 offset:1056
    v_cvt_pk_bf16_f32 v25, v16, v17
    ds_write_b32 v18, v25 offset:1056
    v_pk_mul_f32 v[26:27], v[14:15], v[10:11] op_sel_hi:[1,0]
    v_pk_fma_f32 v[14:15], v[14:15], v[10:11], v[26:27] op_sel:[1,1,0] op_sel_hi:[0,1,1] neg_lo:[1,0,0]
    v_pk_mul_f32 v[28:29], v[16:17], v[12:13] op_sel_hi:[1,0]
    v_pk_fma_f32 v[16:17], v[16:17], v[12:13], v[28:29] op_sel:[1,1,0] op_sel_hi:[0,1,1] neg_lo:[1,0,0]
    v_cvt_pk_bf16_f32 v24, v14, v15
    ds_write_b32 v9, v24 offset:1584
    v_cvt_pk_bf16_f32 v25, v16, v17
    ds_write_b32 v18, v25 offset:1584
    v_pk_mul_f32 v[26:27], v[14:15], v[10:11] op_sel_hi:[1,0]
    v_pk_fma_f32 v[14:15], v[14:15], v[10:11], v[26:27] op_sel:[1,1,0] op_sel_hi:[0,1,1] neg_lo:[1,0,0]
    v_pk_mul_f32 v[28:29], v[16:17], v[12:13] op_sel_hi:[1,0]
    v_pk_fma_f32 v[16:17], v[16:17], v[12:13], v[28:29] op_sel:[1,1,0] op_sel_hi:[0,1,1] neg_lo:[1,0,0]
    v_cvt_pk_bf16_f32 v24, v14, v15
    ds_write_b32 v9, v24 offset:2112
    v_cvt_pk_bf16_f32 v25, v16, v17
    ds_write_b32 v18, v25 offset:2112
    v_pk_mul_f32 v[26:27], v[14:15], v[10:11] op_sel_hi:[1,0]
    v_pk_fma_f32 v[14:15], v[14:15], v[10:11], v[26:27] op_sel:[1,1,0] op_sel_hi:[0,1,1] neg_lo:[1,0,0]
    v_pk_mul_f32 v[28:29], v[16:17], v[12:13] op_sel_hi:[1,0]
    v_pk_fma_f32 v[16:17], v[16:17], v[12:13], v[28:29] op_sel:[1,1,0] op_sel_hi:[0,1,1] neg_lo:[1,0,0]
    v_cvt_pk_bf16_f32 v24, v14, v15
    ds_write_b32 v9, v24 offset:2640
    v_cvt_pk_bf16_f32 v25, v16, v17
    ds_write_b32 v18, v25 offset:2640
    v_pk_mul_f32 v[26:27], v[14:15], v[10:11] op_sel_hi:[1,0]
    v_pk_fma_f32 v[14:15], v[14:15], v[10:11], v[26:27] op_sel:[1,1,0] op_sel_hi:[0,1,1] neg_lo:[1,0,0]
    v_pk_mul_f32 v[28:29], v[16:17], v[12:13] op_sel_hi:[1,0]
    v_pk_fma_f32 v[16:17], v[16:17], v[12:13], v[28:29] op_sel:[1,1,0] op_sel_hi:[0,1,1] neg_lo:[1,0,0]
    v_cvt_pk_bf16_f32 v24, v14, v15
    ds_write_b32 v9, v24 offset:3168
    v_cvt_pk_bf16_f32 v25, v16, v17
    ds_write_b32 v18, v25 offset:3168
    v_pk_mul_f32 v[26:27], v[14:15], v[10:11] op_sel_hi:[1,0]
    v_pk_fma_f32 v[14:15], v[14:15], v[10:11], v[26:27] op_sel:[1,1,0] op_sel_hi:[0,1,1] neg_lo:[1,0,0]
    v_pk_mul_f32 v[28:29], v[16:17], v[12:13] op_sel_hi:[1,0]
    v_pk_fma_f32 v[16:17], v[16:17], v[12:13], v[28:29] op_sel:[1,1,0] op_sel_hi:[0,1,1] neg_lo:[1,0,0]
    v_cvt_pk_bf16_f32 v24, v14, v15
    ds_write_b32 v9, v24 offset:3696
    v_cvt_pk_bf16_f32 v25, v16, v17
    ds_write_b32 v18, v25 offset:3696
    v_pk_mul_f32 v[26:27], v[14:15], v[10:11] op_sel_hi:[1,0]
    v_pk_fma_f32 v[14:15], v[14:15], v[10:11], v[26:27] op_sel:[1,1,0] op_sel_hi:[0,1,1] neg_lo:[1,0,0]
    v_pk_mul_f32 v[28:29], v[16:17], v[12:13] op_sel_hi:[1,0]
    v_pk_fma_f32 v[16:17], v[16:17], v[12:13], v[28:29] op_sel:[1,1,0] op_sel_hi:[0,1,1] neg_lo:[1,0,0]
    v_cvt_pk_bf16_f32 v24, v14, v15
    ds_write_b32 v9, v24 offset:4224
    v_cvt_pk_bf16_f32 v25, v16, v17
    ds_write_b32 v18, v25 offset:4224
    v_pk_mul_f32 v[26:27], v[14:15], v[10:11] op_sel_hi:[1,0]
    v_pk_fma_f32 v[14:15], v[14:15], v[10:11], v[26:27] op_sel:[1,1,0] op_sel_hi:[0,1,1] neg_lo:[1,0,0]
    v_pk_mul_f32 v[28:29], v[16:17], v[12:13] op_sel_hi:[1,0]
    v_pk_fma_f32 v[16:17], v[16:17], v[12:13], v[28:29] op_sel:[1,1,0] op_sel_hi:[0,1,1] neg_lo:[1,0,0]
    v_cvt_pk_bf16_f32 v24, v14, v15
    ds_write_b32 v9, v24 offset:4752
    v_cvt_pk_bf16_f32 v25, v16, v17
    ds_write_b32 v18, v25 offset:4752
    v_pk_mul_f32 v[26:27], v[14:15], v[10:11] op_sel_hi:[1,0]
    v_pk_fma_f32 v[14:15], v[14:15], v[10:11], v[26:27] op_sel:[1,1,0] op_sel_hi:[0,1,1] neg_lo:[1,0,0]
    v_pk_mul_f32 v[28:29], v[16:17], v[12:13] op_sel_hi:[1,0]
    v_pk_fma_f32 v[16:17], v[16:17], v[12:13], v[28:29] op_sel:[1,1,0] op_sel_hi:[0,1,1] neg_lo:[1,0,0]
    v_cvt_pk_bf16_f32 v24, v14, v15
    ds_write_b32 v9, v24 offset:5280
    v_cvt_pk_bf16_f32 v25, v16, v17
    ds_write_b32 v18, v25 offset:5280
    v_pk_mul_f32 v[26:27], v[14:15], v[10:11] op_sel_hi:[1,0]
    v_pk_fma_f32 v[14:15], v[14:15], v[10:11], v[26:27] op_sel:[1,1,0] op_sel_hi:[0,1,1] neg_lo:[1,0,0]
    v_pk_mul_f32 v[28:29], v[16:17], v[12:13] op_sel_hi:[1,0]
    v_pk_fma_f32 v[16:17], v[16:17], v[12:13], v[28:29] op_sel:[1,1,0] op_sel_hi:[0,1,1] neg_lo:[1,0,0]
    v_cvt_pk_bf16_f32 v24, v14, v15
    ds_write_b32 v9, v24 offset:5808
    v_cvt_pk_bf16_f32 v25, v16, v17
    ds_write_b32 v18, v25 offset:5808
    v_pk_mul_f32 v[26:27], v[14:15], v[10:11] op_sel_hi:[1,0]
    v_pk_fma_f32 v[14:15], v[14:15], v[10:11], v[26:27] op_sel:[1,1,0] op_sel_hi:[0,1,1] neg_lo:[1,0,0]
    v_pk_mul_f32 v[28:29], v[16:17], v[12:13] op_sel_hi:[1,0]
    v_pk_fma_f32 v[16:17], v[16:17], v[12:13], v[28:29] op_sel:[1,1,0] op_sel_hi:[0,1,1] neg_lo:[1,0,0]
    v_cvt_pk_bf16_f32 v24, v14, v15
    ds_write_b32 v9, v24 offset:6336
    v_cvt_pk_bf16_f32 v25, v16, v17
    ds_write_b32 v18, v25 offset:6336
    v_pk_mul_f32 v[26:27], v[14:15], v[10:11] op_sel_hi:[1,0]
    v_pk_fma_f32 v[14:15], v[14:15], v[10:11], v[26:27] op_sel:[1,1,0] op_sel_hi:[0,1,1] neg_lo:[1,0,0]
    v_pk_mul_f32 v[28:29], v[16:17], v[12:13] op_sel_hi:[1,0]
    v_pk_fma_f32 v[16:17], v[16:17], v[12:13], v[28:29] op_sel:[1,1,0] op_sel_hi:[0,1,1] neg_lo:[1,0,0]
    v_cvt_pk_bf16_f32 v24, v14, v15
    ds_write_b32 v9, v24 offset:6864
    v_cvt_pk_bf16_f32 v25, v16, v17
    ds_write_b32 v18, v25 offset:6864
    v_pk_mul_f32 v[26:27], v[14:15], v[10:11] op_sel_hi:[1,0]
    v_pk_fma_f32 v[14:15], v[14:15], v[10:11], v[26:27] op_sel:[1,1,0] op_sel_hi:[0,1,1] neg_lo:[1,0,0]
    v_pk_mul_f32 v[28:29], v[16:17], v[12:13] op_sel_hi:[1,0]
    v_pk_fma_f32 v[16:17], v[16:17], v[12:13], v[28:29] op_sel:[1,1,0] op_sel_hi:[0,1,1] neg_lo:[1,0,0]
    v_cvt_pk_bf16_f32 v24, v14, v15
    ds_write_b32 v9, v24 offset:7392
    v_cvt_pk_bf16_f32 v25, v16, v17
    ds_write_b32 v18, v25 offset:7392
    v_pk_mul_f32 v[26:27], v[14:15], v[10:11] op_sel_hi:[1,0]
    v_pk_fma_f32 v[14:15], v[14:15], v[10:11], v[26:27] op_sel:[1,1,0] op_sel_hi:[0,1,1] neg_lo:[1,0,0]
    v_pk_mul_f32 v[28:29], v[16:17], v[12:13] op_sel_hi:[1,0]
    v_pk_fma_f32 v[16:17], v[16:17], v[12:13], v[28:29] op_sel:[1,1,0] op_sel_hi:[0,1,1] neg_lo:[1,0,0]
    v_cvt_pk_bf16_f32 v24, v14, v15
    ds_write_b32 v9, v24 offset:7920
    v_cvt_pk_bf16_f32 v25, v16, v17
    ds_write_b32 v18, v25 offset:7920
    v_pk_mul_f32 v[28:29], v[16:17], v[12:13] op_sel_hi:[1,0]
    v_pk_fma_f32 v[16:17], v[16:17], v[12:13], v[28:29] op_sel:[1,1,0] op_sel_hi:[0,1,1] neg_lo:[1,0,0]
    v_cvt_pk_bf16_f32 v25, v16, v17
    ds_write_b32 v18, v25 offset:8448
    v_pk_mul_f32 v[28:29], v[16:17], v[12:13] op_sel_hi:[1,0]
    v_pk_fma_f32 v[16:17], v[16:17], v[12:13], v[28:29] op_sel:[1,1,0] op_sel_hi:[0,1,1] neg_lo:[1,0,0]
    v_cvt_pk_bf16_f32 v25, v16, v17
    ds_write_b32 v18, v25 offset:8976
    v_pk_mul_f32 v[28:29], v[16:17], v[12:13] op_sel_hi:[1,0]
    v_pk_fma_f32 v[16:17], v[16:17], v[12:13], v[28:29] op_sel:[1,1,0] op_sel_hi:[0,1,1] neg_lo:[1,0,0]
    v_cvt_pk_bf16_f32 v25, v16, v17
    ds_write_b32 v18, v25 offset:9504
    v_pk_mul_f32 v[28:29], v[16:17], v[12:13] op_sel_hi:[1,0]
    v_pk_fma_f32 v[16:17], v[16:17], v[12:13], v[28:29] op_sel:[1,1,0] op_sel_hi:[0,1,1] neg_lo:[1,0,0]
    v_cvt_pk_bf16_f32 v25, v16, v17
    ds_write_b32 v18, v25 offset:10032
    v_pk_mul_f32 v[28:29], v[16:17], v[12:13] op_sel_hi:[1,0]
    v_pk_fma_f32 v[16:17], v[16:17], v[12:13], v[28:29] op_sel:[1,1,0] op_sel_hi:[0,1,1] neg_lo:[1,0,0]
    v_cvt_pk_bf16_f32 v25, v16, v17
    ds_write_b32 v18, v25 offset:10560
    v_pk_mul_f32 v[28:29], v[16:17], v[12:13] op_sel_hi:[1,0]
    v_pk_fma_f32 v[16:17], v[16:17], v[12:13], v[28:29] op_sel:[1,1,0] op_sel_hi:[0,1,1] neg_lo:[1,0,0]
    v_cvt_pk_bf16_f32 v25, v16, v17
    ds_write_b32 v18, v25 offset:11088
    v_pk_mul_f32 v[28:29], v[16:17], v[12:13] op_sel_hi:[1,0]
    v_pk_fma_f32 v[16:17], v[16:17], v[12:13], v[28:29] op_sel:[1,1,0] op_sel_hi:[0,1,1] neg_lo:[1,0,0]
    v_cvt_pk_bf16_f32 v25, v16, v17
    ds_write_b32 v18, v25 offset:11616
    v_pk_mul_f32 v[28:29], v[16:17], v[12:13] op_sel_hi:[1,0]
    v_pk_fma_f32 v[16:17], v[16:17], v[12:13], v[28:29] op_sel:[1,1,0] op_sel_hi:[0,1,1] neg_lo:[1,0,0]
    v_cvt_pk_bf16_f32 v25, v16, v17
    ds_write_b32 v18, v25 offset:12144
    v_pk_mul_f32 v[28:29], v[16:17], v[12:13] op_sel_hi:[1,0]
    v_pk_fma_f32 v[16:17], v[16:17], v[12:13], v[28:29] op_sel:[1,1,0] op_sel_hi:[0,1,1] neg_lo:[1,0,0]
    v_cvt_pk_bf16_f32 v25, v16, v17
    ds_write_b32 v18, v25 offset:12672
    v_pk_mul_f32 v[28:29], v[16:17], v[12:13] op_sel_hi:[1,0]
    v_pk_fma_f32 v[16:17], v[16:17], v[12:13], v[28:29] op_sel:[1,1,0] op_sel_hi:[0,1,1] neg_lo:[1,0,0]
    v_cvt_pk_bf16_f32 v25, v16, v17
    ds_write_b32 v18, v25 offset:13200
    v_pk_mul_f32 v[28:29], v[16:17], v[12:13] op_sel_hi:[1,0]
    v_pk_fma_f32 v[16:17], v[16:17], v[12:13], v[28:29] op_sel:[1,1,0] op_sel_hi:[0,1,1] neg_lo:[1,0,0]
    v_cvt_pk_bf16_f32 v25, v16, v17
    ds_write_b32 v18, v25 offset:13728
    v_pk_mul_f32 v[28:29], v[16:17], v[12:13] op_sel_hi:[1,0]
    v_pk_fma_f32 v[16:17], v[16:17], v[12:13], v[28:29] op_sel:[1,1,0] op_sel_hi:[0,1,1] neg_lo:[1,0,0]
    v_cvt_pk_bf16_f32 v25, v16, v17
    ds_write_b32 v18, v25 offset:14256
    v_pk_mul_f32 v[28:29], v[16:17], v[12:13] op_sel_hi:[1,0]
    v_pk_fma_f32 v[16:17], v[16:17], v[12:13], v[28:29] op_sel:[1,1,0] op_sel_hi:[0,1,1] neg_lo:[1,0,0]
    v_cvt_pk_bf16_f32 v25, v16, v17
    ds_write_b32 v18, v25 offset:14784
    v_pk_mul_f32 v[28:29], v[16:17], v[12:13] op_sel_hi:[1,0]
    v_pk_fma_f32 v[16:17], v[16:17], v[12:13], v[28:29] op_sel:[1,1,0] op_sel_hi:[0,1,1] neg_lo:[1,0,0]
    v_cvt_pk_bf16_f32 v25, v16, v17
    ds_write_b32 v18, v25 offset:15312
    v_pk_mul_f32 v[28:29], v[16:17], v[12:13] op_sel_hi:[1,0]
    v_pk_fma_f32 v[16:17], v[16:17], v[12:13], v[28:29] op_sel:[1,1,0] op_sel_hi:[0,1,1] neg_lo:[1,0,0]
    v_cvt_pk_bf16_f32 v25, v16, v17
    ds_write_b32 v18, v25 offset:15840
    v_pk_mul_f32 v[28:29], v[16:17], v[12:13] op_sel_hi:[1,0]
    v_pk_fma_f32 v[16:17], v[16:17], v[12:13], v[28:29] op_sel:[1,1,0] op_sel_hi:[0,1,1] neg_lo:[1,0,0]
    v_cvt_pk_bf16_f32 v25, v16, v17
    ds_write_b32 v18, v25 offset:16368
    s_branch K1_KG_J_0
K1_KG_P1_0:
    v_mul_f32 v20, 3288334336, v5
    v_mul_f32 v21, 1140850688, v6
    v_exp_f32 v20, v20
    v_fract_f32 v21, v21
    v_cos_f32 v12, v21
    v_sin_f32 v13, v21
    s_nop 0
    v_mul_f32 v12, v20, v12
    v_mul_f32 v13, -v20, v13
    v_mul_f32 v14, v7, v12
    v_mul_f32 v15, v7, v13
    v_fma_f32 v14, v8, v13, v14
    v_fma_f32 v15, -v8, v12, v15
    v_mul_f32 v20, 3298820096, v5
    v_mul_f32 v21, 1151336448, v6
    v_exp_f32 v20, v20
    v_fract_f32 v21, v21
    v_cos_f32 v12, v21
    v_sin_f32 v13, v21
    s_nop 0
    v_mul_f32 v12, v20, v12
    v_mul_f32 v13, -v20, v13
    v_mul_f32 v16, v7, v12
    v_mul_f32 v17, v7, v13
    v_fma_f32 v16, v8, v13, v16
    v_fma_f32 v17, -v8, v12, v17
    v_add_u32 v9, 8448, v23
    v_add_u32 v18, 21120, v23
    v_cvt_pk_bf16_f32 v24, v14, v15
    ds_write_b32 v9, v24 offset:0
    v_cvt_pk_bf16_f32 v25, v16, v17
    ds_write_b32 v18, v25 offset:0
    v_pk_mul_f32 v[26:27], v[14:15], v[10:11] op_sel_hi:[1,0]
    v_pk_fma_f32 v[14:15], v[14:15], v[10:11], v[26:27] op_sel:[1,1,0] op_sel_hi:[0,1,1] neg_lo:[1,0,0]
    v_pk_mul_f32 v[28:29], v[16:17], v[10:11] op_sel_hi:[1,0]
    v_pk_fma_f32 v[16:17], v[16:17], v[10:11], v[28:29] op_sel:[1,1,0] op_sel_hi:[0,1,1] neg_lo:[1,0,0]
    v_cvt_pk_bf16_f32 v24, v14, v15
    ds_write_b32 v9, v24 offset:528
    v_cvt_pk_bf16_f32 v25, v16, v17
    ds_write_b32 v18, v25 offset:528
    v_pk_mul_f32 v[26:27], v[14:15], v[10:11] op_sel_hi:[1,0]
    v_pk_fma_f32 v[14:15], v[14:15], v[10:11], v[26:27] op_sel:[1,1,0] op_sel_hi:[0,1,1] neg_lo:[1,0,0]
    v_pk_mul_f32 v[28:29], v[16:17], v[10:11] op_sel_hi:[1,0]
    v_pk_fma_f32 v[16:17], v[16:17], v[10:11], v[28:29] op_sel:[1,1,0] op_sel_hi:[0,1,1] neg_lo:[1,0,0]
    v_cvt_pk_bf16_f32 v24, v14, v15
    ds_write_b32 v9, v24 offset:1056
    v_cvt_pk_bf16_f32 v25, v16, v17
    ds_write_b32 v18, v25 offset:1056
    v_pk_mul_f32 v[26:27], v[14:15], v[10:11] op_sel_hi:[1,0]
    v_pk_fma_f32 v[14:15], v[14:15], v[10:11], v[26:27] op_sel:[1,1,0] op_sel_hi:[0,1,1] neg_lo:[1,0,0]
    v_pk_mul_f32 v[28:29], v[16:17], v[10:11] op_sel_hi:[1,0]
    v_pk_fma_f32 v[16:17], v[16:17], v[10:11], v[28:29] op_sel:[1,1,0] op_sel_hi:[0,1,1] neg_lo:[1,0,0]
    v_cvt_pk_bf16_f32 v24, v14, v15
    ds_write_b32 v9, v24 offset:1584
    v_cvt_pk_bf16_f32 v25, v16, v17
    ds_write_b32 v18, v25 offset:1584
    v_pk_mul_f32 v[26:27], v[14:15], v[10:11] op_sel_hi:[1,0]
    v_pk_fma_f32 v[14:15], v[14:15], v[10:11], v[26:27] op_sel:[1,1,0] op_sel_hi:[0,1,1] neg_lo:[1,0,0]
    v_pk_mul_f32 v[28:29], v[16:17], v[10:11] op_sel_hi:[1,0]
    v_pk_fma_f32 v[16:17], v[16:17], v[10:11], v[28:29] op_sel:[1,1,0] op_sel_hi:[0,1,1] neg_lo:[1,0,0]
    v_cvt_pk_bf16_f32 v24, v14, v15
    ds_write_b32 v9, v24 offset:2112
    v_cvt_pk_bf16_f32 v25, v16, v17
    ds_write_b32 v18, v25 offset:2112
    v_pk_mul_f32 v[26:27], v[14:15], v[10:11] op_sel_hi:[1,0]
    v_pk_fma_f32 v[14:15], v[14:15], v[10:11], v[26:27] op_sel:[1,1,0] op_sel_hi:[0,1,1] neg_lo:[1,0,0]
    v_pk_mul_f32 v[28:29], v[16:17], v[10:11] op_sel_hi:[1,0]
    v_pk_fma_f32 v[16:17], v[16:17], v[10:11], v[28:29] op_sel:[1,1,0] op_sel_hi:[0,1,1] neg_lo:[1,0,0]
    v_cvt_pk_bf16_f32 v24, v14, v15
    ds_write_b32 v9, v24 offset:2640
    v_cvt_pk_bf16_f32 v25, v16, v17
    ds_write_b32 v18, v25 offset:2640
    v_pk_mul_f32 v[26:27], v[14:15], v[10:11] op_sel_hi:[1,0]
    v_pk_fma_f32 v[14:15], v[14:15], v[10:11], v[26:27] op_sel:[1,1,0] op_sel_hi:[0,1,1] neg_lo:[1,0,0]
    v_pk_mul_f32 v[28:29], v[16:17], v[10:11] op_sel_hi:[1,0]
    v_pk_fma_f32 v[16:17], v[16:17], v[10:11], v[28:29] op_sel:[1,1,0] op_sel_hi:[0,1,1] neg_lo:[1,0,0]
    v_cvt_pk_bf16_f32 v24, v14, v15
    ds_write_b32 v9, v24 offset:3168
    v_cvt_pk_bf16_f32 v25, v16, v17
    ds_write_b32 v18, v25 offset:3168
    v_pk_mul_f32 v[26:27], v[14:15], v[10:11] op_sel_hi:[1,0]
    v_pk_fma_f32 v[14:15], v[14:15], v[10:11], v[26:27] op_sel:[1,1,0] op_sel_hi:[0,1,1] neg_lo:[1,0,0]
    v_pk_mul_f32 v[28:29], v[16:17], v[10:11] op_sel_hi:[1,0]
    v_pk_fma_f32 v[16:17], v[16:17], v[10:11], v[28:29] op_sel:[1,1,0] op_sel_hi:[0,1,1] neg_lo:[1,0,0]
    v_cvt_pk_bf16_f32 v24, v14, v15
    ds_write_b32 v9, v24 offset:3696
    v_cvt_pk_bf16_f32 v25, v16, v17
    ds_write_b32 v18, v25 offset:3696
    v_pk_mul_f32 v[26:27], v[14:15], v[10:11] op_sel_hi:[1,0]
    v_pk_fma_f32 v[14:15], v[14:15], v[10:11], v[26:27] op_sel:[1,1,0] op_sel_hi:[0,1,1] neg_lo:[1,0,0]
    v_pk_mul_f32 v[28:29], v[16:17], v[10:11] op_sel_hi:[1,0]
    v_pk_fma_f32 v[16:17], v[16:17], v[10:11], v[28:29] op_sel:[1,1,0] op_sel_hi:[0,1,1] neg_lo:[1,0,0]
    v_cvt_pk_bf16_f32 v24, v14, v15
    ds_write_b32 v9, v24 offset:4224
    v_cvt_pk_bf16_f32 v25, v16, v17
    ds_write_b32 v18, v25 offset:4224
    v_pk_mul_f32 v[26:27], v[14:15], v[10:11] op_sel_hi:[1,0]
    v_pk_fma_f32 v[14:15], v[14:15], v[10:11], v[26:27] op_sel:[1,1,0] op_sel_hi:[0,1,1] neg_lo:[1,0,0]
    v_pk_mul_f32 v[28:29], v[16:17], v[10:11] op_sel_hi:[1,0]
    v_pk_fma_f32 v[16:17], v[16:17], v[10:11], v[28:29] op_sel:[1,1,0] op_sel_hi:[0,1,1] neg_lo:[1,0,0]
    v_cvt_pk_bf16_f32 v24, v14, v15
    ds_write_b32 v9, v24 offset:4752
    v_cvt_pk_bf16_f32 v25, v16, v17
    ds_write_b32 v18, v25 offset:4752
    v_pk_mul_f32 v[26:27], v[14:15], v[10:11] op_sel_hi:[1,0]
    v_pk_fma_f32 v[14:15], v[14:15], v[10:11], v[26:27] op_sel:[1,1,0] op_sel_hi:[0,1,1] neg_lo:[1,0,0]
    v_pk_mul_f32 v[28:29], v[16:17], v[10:11] op_sel_hi:[1,0]
    v_pk_fma_f32 v[16:17], v[16:17], v[10:11], v[28:29] op_sel:[1,1,0] op_sel_hi:[0,1,1] neg_lo:[1,0,0]
    v_cvt_pk_bf16_f32 v24, v14, v15
    ds_write_b32 v9, v24 offset:5280
    v_cvt_pk_bf16_f32 v25, v16, v17
    ds_write_b32 v18, v25 offset:5280
    v_pk_mul_f32 v[26:27], v[14:15], v[10:11] op_sel_hi:[1,0]
    v_pk_fma_f32 v[14:15], v[14:15], v[10:11], v[26:27] op_sel:[1,1,0] op_sel_hi:[0,1,1] neg_lo:[1,0,0]
    v_pk_mul_f32 v[28:29], v[16:17], v[10:11] op_sel_hi:[1,0]
    v_pk_fma_f32 v[16:17], v[16:17], v[10:11], v[28:29] op_sel:[1,1,0] op_sel_hi:[0,1,1] neg_lo:[1,0,0]
    v_cvt_pk_bf16_f32 v24, v14, v15
    ds_write_b32 v9, v24 offset:5808
    v_cvt_pk_bf16_f32 v25, v16, v17
    ds_write_b32 v18, v25 offset:5808
    v_pk_mul_f32 v[26:27], v[14:15], v[10:11] op_sel_hi:[1,0]
    v_pk_fma_f32 v[14:15], v[14:15], v[10:11], v[26:27] op_sel:[1,1,0] op_sel_hi:[0,1,1] neg_lo:[1,0,0]
    v_pk_mul_f32 v[28:29], v[16:17], v[10:11] op_sel_hi:[1,0]
    v_pk_fma_f32 v[16:17], v[16:17], v[10:11], v[28:29] op_sel:[1,1,0] op_sel_hi:[0,1,1] neg_lo:[1,0,0]
    v_cvt_pk_bf16_f32 v24, v14, v15
    ds_write_b32 v9, v24 offset:6336
    v_cvt_pk_bf16_f32 v25, v16, v17
    ds_write_b32 v18, v25 offset:6336
    v_pk_mul_f32 v[26:27], v[14:15], v[10:11] op_sel_hi:[1,0]
    v_pk_fma_f32 v[14:15], v[14:15], v[10:11], v[26:27] op_sel:[1,1,0] op_sel_hi:[0,1,1] neg_lo:[1,0,0]
    v_pk_mul_f32 v[28:29], v[16:17], v[10:11] op_sel_hi:[1,0]
    v_pk_fma_f32 v[16:17], v[16:17], v[10:11], v[28:29] op_sel:[1,1,0] op_sel_hi:[0,1,1] neg_lo:[1,0,0]
    v_cvt_pk_bf16_f32 v24, v14, v15
    ds_write_b32 v9, v24 offset:6864
    v_cvt_pk_bf16_f32 v25, v16, v17
    ds_write_b32 v18, v25 offset:6864
    v_pk_mul_f32 v[26:27], v[14:15], v[10:11] op_sel_hi:[1,0]
    v_pk_fma_f32 v[14:15], v[14:15], v[10:11], v[26:27] op_sel:[1,1,0] op_sel_hi:[0,1,1] neg_lo:[1,0,0]
    v_pk_mul_f32 v[28:29], v[16:17], v[10:11] op_sel_hi:[1,0]
    v_pk_fma_f32 v[16:17], v[16:17], v[10:11], v[28:29] op_sel:[1,1,0] op_sel_hi:[0,1,1] neg_lo:[1,0,0]
    v_cvt_pk_bf16_f32 v24, v14, v15
    ds_write_b32 v9, v24 offset:7392
    v_cvt_pk_bf16_f32 v25, v16, v17
    ds_write_b32 v18, v25 offset:7392
    v_pk_mul_f32 v[26:27], v[14:15], v[10:11] op_sel_hi:[1,0]
    v_pk_fma_f32 v[14:15], v[14:15], v[10:11], v[26:27] op_sel:[1,1,0] op_sel_hi:[0,1,1] neg_lo:[1,0,0]
    v_pk_mul_f32 v[28:29], v[16:17], v[10:11] op_sel_hi:[1,0]
    v_pk_fma_f32 v[16:17], v[16:17], v[10:11], v[28:29] op_sel:[1,1,0] op_sel_hi:[0,1,1] neg_lo:[1,0,0]
    v_cvt_pk_bf16_f32 v24, v14, v15
    ds_write_b32 v9, v24 offset:7920
    v_cvt_pk_bf16_f32 v25, v16, v17
    ds_write_b32 v18, v25 offset:7920
    v_pk_mul_f32 v[26:27], v[14:15], v[10:11] op_sel_hi:[1,0]
    v_pk_fma_f32 v[14:15], v[14:15], v[10:11], v[26:27] op_sel:[1,1,0] op_sel_hi:[0,1,1] neg_lo:[1,0,0]
    v_pk_mul_f32 v[28:29], v[16:17], v[10:11] op_sel_hi:[1,0]
    v_pk_fma_f32 v[16:17], v[16:17], v[10:11], v[28:29] op_sel:[1,1,0] op_sel_hi:[0,1,1] neg_lo:[1,0,0]
    v_cvt_pk_bf16_f32 v24, v14, v15
    ds_write_b32 v9, v24 offset:8448
    v_cvt_pk_bf16_f32 v25, v16, v17
    ds_write_b32 v18, v25 offset:8448
    v_pk_mul_f32 v[26:27], v[14:15], v[10:11] op_sel_hi:[1,0]
    v_pk_fma_f32 v[14:15], v[14:15], v[10:11], v[26:27] op_sel:[1,1,0] op_sel_hi:[0,1,1] neg_lo:[1,0,0]
    v_pk_mul_f32 v[28:29], v[16:17], v[10:11] op_sel_hi:[1,0]
    v_pk_fma_f32 v[16:17], v[16:17], v[10:11], v[28:29] op_sel:[1,1,0] op_sel_hi:[0,1,1] neg_lo:[1,0,0]
    v_cvt_pk_bf16_f32 v24, v14, v15
    ds_write_b32 v9, v24 offset:8976
    v_cvt_pk_bf16_f32 v25, v16, v17
    ds_write_b32 v18, v25 offset:8976
    v_pk_mul_f32 v[26:27], v[14:15], v[10:11] op_sel_hi:[1,0]
    v_pk_fma_f32 v[14:15], v[14:15], v[10:11], v[26:27] op_sel:[1,1,0] op_sel_hi:[0,1,1] neg_lo:[1,0,0]
    v_pk_mul_f32 v[28:29], v[16:17], v[10:11] op_sel_hi:[1,0]
    v_pk_fma_f32 v[16:17], v[16:17], v[10:11], v[28:29] op_sel:[1,1,0] op_sel_hi:[0,1,1] neg_lo:[1,0,0]
    v_cvt_pk_bf16_f32 v24, v14, v15
    ds_write_b32 v9, v24 offset:9504
    v_cvt_pk_bf16_f32 v25, v16, v17
    ds_write_b32 v18, v25 offset:9504
    v_pk_mul_f32 v[26:27], v[14:15], v[10:11] op_sel_hi:[1,0]
    v_pk_fma_f32 v[14:15], v[14:15], v[10:11], v[26:27] op_sel:[1,1,0] op_sel_hi:[0,1,1] neg_lo:[1,0,0]
    v_pk_mul_f32 v[28:29], v[16:17], v[10:11] op_sel_hi:[1,0]
    v_pk_fma_f32 v[16:17], v[16:17], v[10:11], v[28:29] op_sel:[1,1,0] op_sel_hi:[0,1,1] neg_lo:[1,0,0]
    v_cvt_pk_bf16_f32 v24, v14, v15
    ds_write_b32 v9, v24 offset:10032
    v_cvt_pk_bf16_f32 v25, v16, v17
    ds_write_b32 v18, v25 offset:10032
    v_pk_mul_f32 v[26:27], v[14:15], v[10:11] op_sel_hi:[1,0]
    v_pk_fma_f32 v[14:15], v[14:15], v[10:11], v[26:27] op_sel:[1,1,0] op_sel_hi:[0,1,1] neg_lo:[1,0,0]
    v_pk_mul_f32 v[28:29], v[16:17], v[10:11] op_sel_hi:[1,0]
    v_pk_fma_f32 v[16:17], v[16:17], v[10:11], v[28:29] op_sel:[1,1,0] op_sel_hi:[0,1,1] neg_lo:[1,0,0]
    v_cvt_pk_bf16_f32 v24, v14, v15
    ds_write_b32 v9, v24 offset:10560
    v_cvt_pk_bf16_f32 v25, v16, v17
    ds_write_b32 v18, v25 offset:10560
    v_pk_mul_f32 v[26:27], v[14:15], v[10:11] op_sel_hi:[1,0]
    v_pk_fma_f32 v[14:15], v[14:15], v[10:11], v[26:27] op_sel:[1,1,0] op_sel_hi:[0,1,1] neg_lo:[1,0,0]
    v_pk_mul_f32 v[28:29], v[16:17], v[10:11] op_sel_hi:[1,0]
    v_pk_fma_f32 v[16:17], v[16:17], v[10:11], v[28:29] op_sel:[1,1,0] op_sel_hi:[0,1,1] neg_lo:[1,0,0]
    v_cvt_pk_bf16_f32 v24, v14, v15
    ds_write_b32 v9, v24 offset:11088
    v_cvt_pk_bf16_f32 v25, v16, v17
    ds_write_b32 v18, v25 offset:11088
    v_pk_mul_f32 v[26:27], v[14:15], v[10:11] op_sel_hi:[1,0]
    v_pk_fma_f32 v[14:15], v[14:15], v[10:11], v[26:27] op_sel:[1,1,0] op_sel_hi:[0,1,1] neg_lo:[1,0,0]
    v_pk_mul_f32 v[28:29], v[16:17], v[10:11] op_sel_hi:[1,0]
    v_pk_fma_f32 v[16:17], v[16:17], v[10:11], v[28:29] op_sel:[1,1,0] op_sel_hi:[0,1,1] neg_lo:[1,0,0]
    v_cvt_pk_bf16_f32 v24, v14, v15
    ds_write_b32 v9, v24 offset:11616
    v_cvt_pk_bf16_f32 v25, v16, v17
    ds_write_b32 v18, v25 offset:11616
    v_pk_mul_f32 v[26:27], v[14:15], v[10:11] op_sel_hi:[1,0]
    v_pk_fma_f32 v[14:15], v[14:15], v[10:11], v[26:27] op_sel:[1,1,0] op_sel_hi:[0,1,1] neg_lo:[1,0,0]
    v_pk_mul_f32 v[28:29], v[16:17], v[10:11] op_sel_hi:[1,0]
    v_pk_fma_f32 v[16:17], v[16:17], v[10:11], v[28:29] op_sel:[1,1,0] op_sel_hi:[0,1,1] neg_lo:[1,0,0]
    v_cvt_pk_bf16_f32 v24, v14, v15
    ds_write_b32 v9, v24 offset:12144
    v_cvt_pk_bf16_f32 v25, v16, v17
    ds_write_b32 v18, v25 offset:12144
K1_KG_J_0:
    s_waitcnt lgkmcnt(0)
    s_barrier
    v_lshrrev_b32 v3, 5, v1
    v_and_b32 v19, 31, v1
    s_movk_i32 s3, 528
    v_and_b32 v20, 1, v2
    v_lshl_add_u32 v20, v20, 5, v19
    v_mul_lo_u32 v20, v20, s3
    v_lshl_add_u32 v20, v3, 4, v20
    s_lshl_b32 s23, s22, 8
    v_add_u32 v20, s23, v20
    v_mul_lo_u32 v21, v19, s3
    v_lshl_add_u32 v21, v3, 4, v21
    v_add_u32 v21, s23, v21
    v_add_u32 v21, 33792, v21
    ds_read_b128 v[48:51], v20 offset:0
    ds_read_b128 v[80:83], v21 offset:0
    ds_read_b128 v[52:55], v20 offset:32
    ds_read_b128 v[84:87], v21 offset:32
    ds_read_b128 v[56:59], v20 offset:64
    ds_read_b128 v[88:91], v21 offset:64
    ds_read_b128 v[60:63], v20 offset:96
    ds_read_b128 v[92:95], v21 offset:96
    ds_read_b128 v[64:67], v20 offset:128
    ds_read_b128 v[96:99], v21 offset:128
    ds_read_b128 v[68:71], v20 offset:160
    ds_read_b128 v[100:103], v21 offset:160
    ds_read_b128 v[72:75], v20 offset:192
    ds_read_b128 v[104:107], v21 offset:192
    ds_read_b128 v[76:79], v20 offset:224
    ds_read_b128 v[108:111], v21 offset:224
    s_waitcnt lgkmcnt(14)
    v_mfma_f32_32x32x16_bf16 v[32:47], v[48:51], v[80:83], 0
    s_waitcnt lgkmcnt(12)
    v_mfma_f32_32x32x16_bf16 v[32:47], v[52:55], v[84:87], v[32:47]
    s_waitcnt lgkmcnt(10)
    v_mfma_f32_32x32x16_bf16 v[32:47], v[56:59], v[88:91], v[32:47]
    s_waitcnt lgkmcnt(8)
    v_mfma_f32_32x32x16_bf16 v[32:47], v[60:63], v[92:95], v[32:47]
    s_waitcnt lgkmcnt(6)
    v_mfma_f32_32x32x16_bf16 v[32:47], v[64:67], v[96:99], v[32:47]
    s_waitcnt lgkmcnt(4)
    v_mfma_f32_32x32x16_bf16 v[32:47], v[68:71], v[100:103], v[32:47]
    s_waitcnt lgkmcnt(2)
    v_mfma_f32_32x32x16_bf16 v[32:47], v[72:75], v[104:107], v[32:47]
    s_waitcnt lgkmcnt(0)
    v_mfma_f32_32x32x16_bf16 v[32:47], v[76:79], v[108:111], v[32:47]
    s_barrier
    s_mul_i32 s24, s22, 8208
    v_lshlrev_b32 v20, 9, v3
    v_lshl_add_u32 v20, v19, 2, v20
    v_add_u32 v20, s24, v20
    s_and_b32 s25, s89, 1
    s_lshl_b32 s25, s25, 12
    v_add_u32 v20, s25, v20
    s_nop 7
    ds_write_b32 v20, v32 offset:4
    ds_write_b32 v20, v33 offset:132
    ds_write_b32 v20, v34 offset:260
    ds_write_b32 v20, v35 offset:388
    ds_write_b32 v20, v36 offset:1028
    ds_write_b32 v20, v37 offset:1156
    ds_write_b32 v20, v38 offset:1284
    ds_write_b32 v20, v39 offset:1412
    ds_write_b32 v20, v40 offset:2052
    ds_write_b32 v20, v41 offset:2180
    ds_write_b32 v20, v42 offset:2308
    ds_write_b32 v20, v43 offset:2436
    ds_write_b32 v20, v44 offset:3076
    ds_write_b32 v20, v45 offset:3204
    ds_write_b32 v20, v46 offset:3332
    ds_write_b32 v20, v47 offset:3460
    s_cmp_eq_u32 s22, 0
    s_cbranch_scc0 K1_KG_NS_0
    v_mov_b32 v22, v7
    s_nop 1
    v_add_f32_dpp v22, v22, v22 row_ror:1 row_mask:0xf bank_mask:0xf
    s_nop 1
    v_add_f32_dpp v22, v22, v22 row_ror:2 row_mask:0xf bank_mask:0xf
    s_nop 1
    v_add_f32_dpp v22, v22, v22 row_ror:4 row_mask:0xf bank_mask:0xf
    s_nop 1
    v_add_f32_dpp v22, v22, v22 row_ror:8 row_mask:0xf bank_mask:0xf
    s_nop 1
    v_readlane_b32 s26, v22, 0
    v_readlane_b32 s27, v22, 16
    v_readlane_b32 s28, v22, 32
    v_readlane_b32 s29, v22, 48
    s_nop 1
    v_mov_b32 v22, s26
    v_add_f32 v22, s27, v22
    v_add_f32 v22, s28, v22
    v_add_f32 v22, s29, v22
    s_and_b32 s25, s89, 1
    s_mul_i32 s25, s25, 8208
    v_mov_b32 v23, s25
    ds_write_b32 v23, v22
K1_KG_NS_0:
    s_waitcnt lgkmcnt(0)
    s_barrier
    v_lshlrev_b32 v20, 3, v0
    v_sub_u32 v21, 2047, v20
    v_subrev_u32 v24, 0, v21
    v_subrev_u32 v25, 1, v21
    v_subrev_u32 v26, 2, v21
    v_subrev_u32 v27, 3, v21
    v_subrev_u32 v28, 4, v21
    v_subrev_u32 v29, 5, v21
    v_subrev_u32 v30, 6, v21
    v_subrev_u32 v31, 7, v21
    v_subrev_u32 v32, 8, v21
    v_cmp_gt_i32 vcc, 0, v32
    v_max_i32 v32, 0, v32
    v_cvt_f32_u32 v24, v24
    v_cvt_f32_u32 v25, v25
    v_cvt_f32_u32 v26, v26
    v_cvt_f32_u32 v27, v27
    v_cvt_f32_u32 v28, v28
    v_cvt_f32_u32 v29, v29
    v_cvt_f32_u32 v30, v30
    v_cvt_f32_u32 v31, v31
    v_cvt_f32_u32 v32, v32
    v_bfe_u32 v22, v24, 16, 1
    v_add3_u32 v24, v24, v22, s90
    v_and_b32 v24, 0xffff0000, v24
    v_bfe_u32 v22, v25, 16, 1
    v_add3_u32 v25, v25, v22, s90
    v_and_b32 v25, 0xffff0000, v25
    v_bfe_u32 v22, v26, 16, 1
    v_add3_u32 v26, v26, v22, s90
    v_and_b32 v26, 0xffff0000, v26
    v_bfe_u32 v22, v27, 16, 1
    v_add3_u32 v27, v27, v22, s90
    v_and_b32 v27, 0xffff0000, v27
    v_bfe_u32 v22, v28, 16, 1
    v_add3_u32 v28, v28, v22, s90
    v_and_b32 v28, 0xffff0000, v28
    v_bfe_u32 v22, v29, 16, 1
    v_add3_u32 v29, v29, v22, s90
    v_and_b32 v29, 0xffff0000, v29
    v_bfe_u32 v22, v30, 16, 1
    v_add3_u32 v30, v30, v22, s90
    v_and_b32 v30, 0xffff0000, v30
    v_bfe_u32 v22, v31, 16, 1
    v_add3_u32 v31, v31, v22, s90
    v_and_b32 v31, 0xffff0000, v31
    v_bfe_u32 v22, v32, 16, 1
    v_add3_u32 v32, v32, v22, s90
    v_and_b32 v32, 0xffff0000, v32
    v_cvt_u32_f32 v24, v24
    v_lshlrev_b32 v24, 2, v24
    v_cvt_u32_f32 v25, v25
    v_lshlrev_b32 v25, 2, v25
    v_cvt_u32_f32 v26, v26
    v_lshlrev_b32 v26, 2, v26
    v_cvt_u32_f32 v27, v27
    v_lshlrev_b32 v27, 2, v27
    v_cvt_u32_f32 v28, v28
    v_lshlrev_b32 v28, 2, v28
    v_cvt_u32_f32 v29, v29
    v_lshlrev_b32 v29, 2, v29
    v_cvt_u32_f32 v30, v30
    v_lshlrev_b32 v30, 2, v30
    v_cvt_u32_f32 v31, v31
    v_lshlrev_b32 v31, 2, v31
    v_cvt_u32_f32 v32, v32
    v_lshlrev_b32 v32, 2, v32
    ds_read_b32 v40, v24
    ds_read_b32 v41, v24 offset:8208
    ds_read_b32 v42, v25
    ds_read_b32 v43, v25 offset:8208
    ds_read_b32 v44, v26
    ds_read_b32 v45, v26 offset:8208
    ds_read_b32 v46, v27
    ds_read_b32 v47, v27 offset:8208
    ds_read_b32 v48, v28
    ds_read_b32 v49, v28 offset:8208
    ds_read_b32 v50, v29
    ds_read_b32 v51, v29 offset:8208
    ds_read_b32 v52, v30
    ds_read_b32 v53, v30 offset:8208
    ds_read_b32 v54, v31
    ds_read_b32 v55, v31 offset:8208
    ds_read_b32 v56, v32
    ds_read_b32 v57, v32 offset:8208
    s_waitcnt lgkmcnt(0)
    v_add_f32 v40, v40, v41
    v_add_f32 v42, v42, v43
    v_add_f32 v44, v44, v45
    v_add_f32 v46, v46, v47
    v_add_f32 v48, v48, v49
    v_add_f32 v50, v50, v51
    v_add_f32 v52, v52, v53
    v_add_f32 v54, v54, v55
    v_add_f32 v56, v56, v57
    v_cndmask_b32 v56, v56, 0, vcc
    v_cvt_pk_bf16_f32 v60, v40, v42
    v_cvt_pk_bf16_f32 v64, v42, v44
    v_cvt_pk_bf16_f32 v61, v44, v46
    v_cvt_pk_bf16_f32 v65, v46, v48
    v_cvt_pk_bf16_f32 v62, v48, v50
    v_cvt_pk_bf16_f32 v66, v50, v52
    v_cvt_pk_bf16_f32 v63, v52, v54
    v_cvt_pk_bf16_f32 v67, v54, v56
    v_mov_b32 v136, v60
    v_mov_b32 v137, v61
    v_mov_b32 v138, v62
    v_mov_b32 v139, v63
    v_mov_b32 v140, v64
    v_mov_b32 v141, v65
    v_mov_b32 v142, v66
    v_mov_b32 v143, v67
    s_barrier
    s_add_u32 s31, s30, 1
    s_waitcnt vmcnt(0)
    v_lshlrev_b32 v4, 16, v125
    v_lshlrev_b32 v5, 16, v126
    v_lshlrev_b32 v6, 16, v127
    v_lshlrev_b32 v7, 16, v128
    v_lshlrev_b32 v8, 16, v129
    v_mov_b32 v23, v119
    v_mul_f32 v4, s20, v4
    v_mul_f32 v5, s20, v5
    v_exp_f32 v4, v4
    v_exp_f32 v5, v5
    s_nop 0
    v_bfe_u32 v20, v4, 16, 1
    v_add3_u32 v4, v4, v20, s90
    v_and_b32 v4, 0xffff0000, v4
    v_bfe_u32 v20, v5, 16, 1
    v_add3_u32 v5, v5, v20, s90
    v_and_b32 v5, 0xffff0000, v5
    v_mul_f32 v5, v4, v5
    v_mul_f32 v6, v4, v6
    v_mul_f32 v5, s20, v5
    v_mul_f32 v6, s21, v6
    v_mul_f32 v7, v4, v7
    v_mul_f32 v8, v4, v8
    v_add_f32 v7, v7, v7
    v_add_f32 v8, v8, v8
    v_mul_f32 v20, 3254779904, v5
    v_mul_f32 v21, 1107296256, v6
    v_exp_f32 v20, v20
    v_fract_f32 v21, v21
    v_cos_f32 v10, v21
    v_sin_f32 v11, v21
    s_nop 0
    v_mul_f32 v10, v20, v10
    v_mul_f32 v11, -v20, v11
    s_cmp_eq_u32 s22, 0
    s_cbranch_scc0 K1_KG_P1_1
    v_mul_f32 v20, 3212836864, v5
    v_mul_f32 v21, 1065353216, v6
    v_exp_f32 v20, v20
    v_fract_f32 v21, v21
    v_cos_f32 v12, v21
    v_sin_f32 v13, v21
    s_nop 0
    v_mul_f32 v12, v20, v12
    v_mul_f32 v13, v20, v13
    v_mov_b32 v14, v7
    v_sub_f32 v15, 0, v8
    v_mov_b32 v16, v12
    v_mov_b32 v17, v13
    v_mov_b32 v9, v23
    v_add_u32 v18, 33792, v23
    v_cvt_pk_bf16_f32 v24, v14, v15
    ds_write_b32 v9, v24 offset:0
    v_cvt_pk_bf16_f32 v25, v16, v17
    ds_write_b32 v18, v25 offset:0
    v_pk_mul_f32 v[26:27], v[14:15], v[10:11] op_sel_hi:[1,0]
    v_pk_fma_f32 v[14:15], v[14:15], v[10:11], v[26:27] op_sel:[1,1,0] op_sel_hi:[0,1,1] neg_lo:[1,0,0]
    v_pk_mul_f32 v[28:29], v[16:17], v[12:13] op_sel_hi:[1,0]
    v_pk_fma_f32 v[16:17], v[16:17], v[12:13], v[28:29] op_sel:[1,1,0] op_sel_hi:[0,1,1] neg_lo:[1,0,0]
    v_cvt_pk_bf16_f32 v24, v14, v15
    ds_write_b32 v9, v24 offset:528
    v_cvt_pk_bf16_f32 v25, v16, v17
    ds_write_b32 v18, v25 offset:528
    v_pk_mul_f32 v[26:27], v[14:15], v[10:11] op_sel_hi:[1,0]
    v_pk_fma_f32 v[14:15], v[14:15], v[10:11], v[26:27] op_sel:[1,1,0] op_sel_hi:[0,1,1] neg_lo:[1,0,0]
    v_pk_mul_f32 v[28:29], v[16:17], v[12:13] op_sel_hi:[1,0]
    v_pk_fma_f32 v[16:17], v[16:17], v[12:13], v[28:29] op_sel:[1,1,0] op_sel_hi:[0,1,1] neg_lo:[1,0,0]
    v_cvt_pk_bf16_f32 v24, v14, v15
    ds_write_b32 v9, v24 offset:1056
    v_cvt_pk_bf16_f32 v25, v16, v17
    ds_write_b32 v18, v25 offset:1056
    v_pk_mul_f32 v[26:27], v[14:15], v[10:11] op_sel_hi:[1,0]
    v_pk_fma_f32 v[14:15], v[14:15], v[10:11], v[26:27] op_sel:[1,1,0] op_sel_hi:[0,1,1] neg_lo:[1,0,0]
    v_pk_mul_f32 v[28:29], v[16:17], v[12:13] op_sel_hi:[1,0]
    v_pk_fma_f32 v[16:17], v[16:17], v[12:13], v[28:29] op_sel:[1,1,0] op_sel_hi:[0,1,1] neg_lo:[1,0,0]
    v_cvt_pk_bf16_f32 v24, v14, v15
    ds_write_b32 v9, v24 offset:1584
    v_cvt_pk_bf16_f32 v25, v16, v17
    ds_write_b32 v18, v25 offset:1584
    v_pk_mul_f32 v[26:27], v[14:15], v[10:11] op_sel_hi:[1,0]
    v_pk_fma_f32 v[14:15], v[14:15], v[10:11], v[26:27] op_sel:[1,1,0] op_sel_hi:[0,1,1] neg_lo:[1,0,0]
    v_pk_mul_f32 v[28:29], v[16:17], v[12:13] op_sel_hi:[1,0]
    v_pk_fma_f32 v[16:17], v[16:17], v[12:13], v[28:29] op_sel:[1,1,0] op_sel_hi:[0,1,1] neg_lo:[1,0,0]
    v_cvt_pk_bf16_f32 v24, v14, v15
    ds_write_b32 v9, v24 offset:2112
    v_cvt_pk_bf16_f32 v25, v16, v17
    ds_write_b32 v18, v25 offset:2112
    v_pk_mul_f32 v[26:27], v[14:15], v[10:11] op_sel_hi:[1,0]
    v_pk_fma_f32 v[14:15], v[14:15], v[10:11], v[26:27] op_sel:[1,1,0] op_sel_hi:[0,1,1] neg_lo:[1,0,0]
    v_pk_mul_f32 v[28:29], v[16:17], v[12:13] op_sel_hi:[1,0]
    v_pk_fma_f32 v[16:17], v[16:17], v[12:13], v[28:29] op_sel:[1,1,0] op_sel_hi:[0,1,1] neg_lo:[1,0,0]
    v_cvt_pk_bf16_f32 v24, v14, v15
    ds_write_b32 v9, v24 offset:2640
    v_cvt_pk_bf16_f32 v25, v16, v17
    ds_write_b32 v18, v25 offset:2640
    v_pk_mul_f32 v[26:27], v[14:15], v[10:11] op_sel_hi:[1,0]
    v_pk_fma_f32 v[14:15], v[14:15], v[10:11], v[26:27] op_sel:[1,1,0] op_sel_hi:[0,1,1] neg_lo:[1,0,0]
    v_pk_mul_f32 v[28:29], v[16:17], v[12:13] op_sel_hi:[1,0]
    v_pk_fma_f32 v[16:17], v[16:17], v[12:13], v[28:29] op_sel:[1,1,0] op_sel_hi:[0,1,1] neg_lo:[1,0,0]
    v_cvt_pk_bf16_f32 v24, v14, v15
    ds_write_b32 v9, v24 offset:3168
    v_cvt_pk_bf16_f32 v25, v16, v17
    ds_write_b32 v18, v25 offset:3168
    v_pk_mul_f32 v[26:27], v[14:15], v[10:11] op_sel_hi:[1,0]
    v_pk_fma_f32 v[14:15], v[14:15], v[10:11], v[26:27] op_sel:[1,1,0] op_sel_hi:[0,1,1] neg_lo:[1,0,0]
    v_pk_mul_f32 v[28:29], v[16:17], v[12:13] op_sel_hi:[1,0]
    v_pk_fma_f32 v[16:17], v[16:17], v[12:13], v[28:29] op_sel:[1,1,0] op_sel_hi:[0,1,1] neg_lo:[1,0,0]
    v_cvt_pk_bf16_f32 v24, v14, v15
    ds_write_b32 v9, v24 offset:3696
    v_cvt_pk_bf16_f32 v25, v16, v17
    ds_write_b32 v18, v25 offset:3696
    v_pk_mul_f32 v[26:27], v[14:15], v[10:11] op_sel_hi:[1,0]
    v_pk_fma_f32 v[14:15], v[14:15], v[10:11], v[26:27] op_sel:[1,1,0] op_sel_hi:[0,1,1] neg_lo:[1,0,0]
    v_pk_mul_f32 v[28:29], v[16:17], v[12:13] op_sel_hi:[1,0]
    v_pk_fma_f32 v[16:17], v[16:17], v[12:13], v[28:29] op_sel:[1,1,0] op_sel_hi:[0,1,1] neg_lo:[1,0,0]
    v_cvt_pk_bf16_f32 v24, v14, v15
    ds_write_b32 v9, v24 offset:4224
    v_cvt_pk_bf16_f32 v25, v16, v17
    ds_write_b32 v18, v25 offset:4224
    v_pk_mul_f32 v[26:27], v[14:15], v[10:11] op_sel_hi:[1,0]
    v_pk_fma_f32 v[14:15], v[14:15], v[10:11], v[26:27] op_sel:[1,1,0] op_sel_hi:[0,1,1] neg_lo:[1,0,0]
    v_pk_mul_f32 v[28:29], v[16:17], v[12:13] op_sel_hi:[1,0]
    v_pk_fma_f32 v[16:17], v[16:17], v[12:13], v[28:29] op_sel:[1,1,0] op_sel_hi:[0,1,1] neg_lo:[1,0,0]
    v_cvt_pk_bf16_f32 v24, v14, v15
    ds_write_b32 v9, v24 offset:4752
    v_cvt_pk_bf16_f32 v25, v16, v17
    ds_write_b32 v18, v25 offset:4752
    v_pk_mul_f32 v[26:27], v[14:15], v[10:11] op_sel_hi:[1,0]
    v_pk_fma_f32 v[14:15], v[14:15], v[10:11], v[26:27] op_sel:[1,1,0] op_sel_hi:[0,1,1] neg_lo:[1,0,0]
    v_pk_mul_f32 v[28:29], v[16:17], v[12:13] op_sel_hi:[1,0]
    v_pk_fma_f32 v[16:17], v[16:17], v[12:13], v[28:29] op_sel:[1,1,0] op_sel_hi:[0,1,1] neg_lo:[1,0,0]
    v_cvt_pk_bf16_f32 v24, v14, v15
    ds_write_b32 v9, v24 offset:5280
    v_cvt_pk_bf16_f32 v25, v16, v17
    ds_write_b32 v18, v25 offset:5280
    v_pk_mul_f32 v[26:27], v[14:15], v[10:11] op_sel_hi:[1,0]
    v_pk_fma_f32 v[14:15], v[14:15], v[10:11], v[26:27] op_sel:[1,1,0] op_sel_hi:[0,1,1] neg_lo:[1,0,0]
    v_pk_mul_f32 v[28:29], v[16:17], v[12:13] op_sel_hi:[1,0]
    v_pk_fma_f32 v[16:17], v[16:17], v[12:13], v[28:29] op_sel:[1,1,0] op_sel_hi:[0,1,1] neg_lo:[1,0,0]
    v_cvt_pk_bf16_f32 v24, v14, v15
    ds_write_b32 v9, v24 offset:5808
    v_cvt_pk_bf16_f32 v25, v16, v17
    ds_write_b32 v18, v25 offset:5808
    v_pk_mul_f32 v[26:27], v[14:15], v[10:11] op_sel_hi:[1,0]
    v_pk_fma_f32 v[14:15], v[14:15], v[10:11], v[26:27] op_sel:[1,1,0] op_sel_hi:[0,1,1] neg_lo:[1,0,0]
    v_pk_mul_f32 v[28:29], v[16:17], v[12:13] op_sel_hi:[1,0]
    v_pk_fma_f32 v[16:17], v[16:17], v[12:13], v[28:29] op_sel:[1,1,0] op_sel_hi:[0,1,1] neg_lo:[1,0,0]
    v_cvt_pk_bf16_f32 v24, v14, v15
    ds_write_b32 v9, v24 offset:6336
    v_cvt_pk_bf16_f32 v25, v16, v17
    ds_write_b32 v18, v25 offset:6336
    v_pk_mul_f32 v[26:27], v[14:15], v[10:11] op_sel_hi:[1,0]
    v_pk_fma_f32 v[14:15], v[14:15], v[10:11], v[26:27] op_sel:[1,1,0] op_sel_hi:[0,1,1] neg_lo:[1,0,0]
    v_pk_mul_f32 v[28:29], v[16:17], v[12:13] op_sel_hi:[1,0]
    v_pk_fma_f32 v[16:17], v[16:17], v[12:13], v[28:29] op_sel:[1,1,0] op_sel_hi:[0,1,1] neg_lo:[1,0,0]
    v_cvt_pk_bf16_f32 v24, v14, v15
    ds_write_b32 v9, v24 offset:6864
    v_cvt_pk_bf16_f32 v25, v16, v17
    ds_write_b32 v18, v25 offset:6864
    v_pk_mul_f32 v[26:27], v[14:15], v[10:11] op_sel_hi:[1,0]
    v_pk_fma_f32 v[14:15], v[14:15], v[10:11], v[26:27] op_sel:[1,1,0] op_sel_hi:[0,1,1] neg_lo:[1,0,0]
    v_pk_mul_f32 v[28:29], v[16:17], v[12:13] op_sel_hi:[1,0]
    v_pk_fma_f32 v[16:17], v[16:17], v[12:13], v[28:29] op_sel:[1,1,0] op_sel_hi:[0,1,1] neg_lo:[1,0,0]
    v_cvt_pk_bf16_f32 v24, v14, v15
    ds_write_b32 v9, v24 offset:7392
    v_cvt_pk_bf16_f32 v25, v16, v17
    ds_write_b32 v18, v25 offset:7392
    v_pk_mul_f32 v[26:27], v[14:15], v[10:11] op_sel_hi:[1,0]
    v_pk_fma_f32 v[14:15], v[14:15], v[10:11], v[26:27] op_sel:[1,1,0] op_sel_hi:[0,1,1] neg_lo:[1,0,0]
    v_pk_mul_f32 v[28:29], v[16:17], v[12:13] op_sel_hi:[1,0]
    v_pk_fma_f32 v[16:17], v[16:17], v[12:13], v[28:29] op_sel:[1,1,0] op_sel_hi:[0,1,1] neg_lo:[1,0,0]
    v_cvt_pk_bf16_f32 v24, v14, v15
    ds_write_b32 v9, v24 offset:7920
    v_cvt_pk_bf16_f32 v25, v16, v17
    ds_write_b32 v18, v25 offset:7920
    v_pk_mul_f32 v[28:29], v[16:17], v[12:13] op_sel_hi:[1,0]
    v_pk_fma_f32 v[16:17], v[16:17], v[12:13], v[28:29] op_sel:[1,1,0] op_sel_hi:[0,1,1] neg_lo:[1,0,0]
    v_cvt_pk_bf16_f32 v25, v16, v17
    ds_write_b32 v18, v25 offset:8448
    v_pk_mul_f32 v[28:29], v[16:17], v[12:13] op_sel_hi:[1,0]
    v_pk_fma_f32 v[16:17], v[16:17], v[12:13], v[28:29] op_sel:[1,1,0] op_sel_hi:[0,1,1] neg_lo:[1,0,0]
    v_cvt_pk_bf16_f32 v25, v16, v17
    ds_write_b32 v18, v25 offset:8976
    v_pk_mul_f32 v[28:29], v[16:17], v[12:13] op_sel_hi:[1,0]
    v_pk_fma_f32 v[16:17], v[16:17], v[12:13], v[28:29] op_sel:[1,1,0] op_sel_hi:[0,1,1] neg_lo:[1,0,0]
    v_cvt_pk_bf16_f32 v25, v16, v17
    ds_write_b32 v18, v25 offset:9504
    v_pk_mul_f32 v[28:29], v[16:17], v[12:13] op_sel_hi:[1,0]
    v_pk_fma_f32 v[16:17], v[16:17], v[12:13], v[28:29] op_sel:[1,1,0] op_sel_hi:[0,1,1] neg_lo:[1,0,0]
    v_cvt_pk_bf16_f32 v25, v16, v17
    ds_write_b32 v18, v25 offset:10032
    v_pk_mul_f32 v[28:29], v[16:17], v[12:13] op_sel_hi:[1,0]
    v_pk_fma_f32 v[16:17], v[16:17], v[12:13], v[28:29] op_sel:[1,1,0] op_sel_hi:[0,1,1] neg_lo:[1,0,0]
    v_cvt_pk_bf16_f32 v25, v16, v17
    ds_write_b32 v18, v25 offset:10560
    v_pk_mul_f32 v[28:29], v[16:17], v[12:13] op_sel_hi:[1,0]
    v_pk_fma_f32 v[16:17], v[16:17], v[12:13], v[28:29] op_sel:[1,1,0] op_sel_hi:[0,1,1] neg_lo:[1,0,0]
    v_cvt_pk_bf16_f32 v25, v16, v17
    ds_write_b32 v18, v25 offset:11088
    v_pk_mul_f32 v[28:29], v[16:17], v[12:13] op_sel_hi:[1,0]
    v_pk_fma_f32 v[16:17], v[16:17], v[12:13], v[28:29] op_sel:[1,1,0] op_sel_hi:[0,1,1] neg_lo:[1,0,0]
    v_cvt_pk_bf16_f32 v25, v16, v17
    ds_write_b32 v18, v25 offset:11616
    v_pk_mul_f32 v[28:29], v[16:17], v[12:13] op_sel_hi:[1,0]
    v_pk_fma_f32 v[16:17], v[16:17], v[12:13], v[28:29] op_sel:[1,1,0] op_sel_hi:[0,1,1] neg_lo:[1,0,0]
    v_cvt_pk_bf16_f32 v25, v16, v17
    ds_write_b32 v18, v25 offset:12144
    v_pk_mul_f32 v[28:29], v[16:17], v[12:13] op_sel_hi:[1,0]
    v_pk_fma_f32 v[16:17], v[16:17], v[12:13], v[28:29] op_sel:[1,1,0] op_sel_hi:[0,1,1] neg_lo:[1,0,0]
    v_cvt_pk_bf16_f32 v25, v16, v17
    ds_write_b32 v18, v25 offset:12672
    v_pk_mul_f32 v[28:29], v[16:17], v[12:13] op_sel_hi:[1,0]
    v_pk_fma_f32 v[16:17], v[16:17], v[12:13], v[28:29] op_sel:[1,1,0] op_sel_hi:[0,1,1] neg_lo:[1,0,0]
    v_cvt_pk_bf16_f32 v25, v16, v17
    ds_write_b32 v18, v25 offset:13200
    v_pk_mul_f32 v[28:29], v[16:17], v[12:13] op_sel_hi:[1,0]
    v_pk_fma_f32 v[16:17], v[16:17], v[12:13], v[28:29] op_sel:[1,1,0] op_sel_hi:[0,1,1] neg_lo:[1,0,0]
    v_cvt_pk_bf16_f32 v25, v16, v17
    ds_write_b32 v18, v25 offset:13728
    v_pk_mul_f32 v[28:29], v[16:17], v[12:13] op_sel_hi:[1,0]
    v_pk_fma_f32 v[16:17], v[16:17], v[12:13], v[28:29] op_sel:[1,1,0] op_sel_hi:[0,1,1] neg_lo:[1,0,0]
    v_cvt_pk_bf16_f32 v25, v16, v17
    ds_write_b32 v18, v25 offset:14256
    v_pk_mul_f32 v[28:29], v[16:17], v[12:13] op_sel_hi:[1,0]
    v_pk_fma_f32 v[16:17], v[16:17], v[12:13], v[28:29] op_sel:[1,1,0] op_sel_hi:[0,1,1] neg_lo:[1,0,0]
    v_cvt_pk_bf16_f32 v25, v16, v17
    ds_write_b32 v18, v25 offset:14784
    v_pk_mul_f32 v[28:29], v[16:17], v[12:13] op_sel_hi:[1,0]
    v_pk_fma_f32 v[16:17], v[16:17], v[12:13], v[28:29] op_sel:[1,1,0] op_sel_hi:[0,1,1] neg_lo:[1,0,0]
    v_cvt_pk_bf16_f32 v25, v16, v17
    ds_write_b32 v18, v25 offset:15312
    v_pk_mul_f32 v[28:29], v[16:17], v[12:13] op_sel_hi:[1,0]
    v_pk_fma_f32 v[16:17], v[16:17], v[12:13], v[28:29] op_sel:[1,1,0] op_sel_hi:[0,1,1] neg_lo:[1,0,0]
    v_cvt_pk_bf16_f32 v25, v16, v17
    ds_write_b32 v18, v25 offset:15840
    v_pk_mul_f32 v[28:29], v[16:17], v[12:13] op_sel_hi:[1,0]
    v_pk_fma_f32 v[16:17], v[16:17], v[12:13], v[28:29] op_sel:[1,1,0] op_sel_hi:[0,1,1] neg_lo:[1,0,0]
    v_cvt_pk_bf16_f32 v25, v16, v17
    ds_write_b32 v18, v25 offset:16368
    s_branch K1_KG_J_1
K1_KG_P1_1:
    v_mul_f32 v20, 3288334336, v5
    v_mul_f32 v21, 1140850688, v6
    v_exp_f32 v20, v20
    v_fract_f32 v21, v21
    v_cos_f32 v12, v21
    v_sin_f32 v13, v21
    s_nop 0
    v_mul_f32 v12, v20, v12
    v_mul_f32 v13, -v20, v13
    v_mul_f32 v14, v7, v12
    v_mul_f32 v15, v7, v13
    v_fma_f32 v14, v8, v13, v14
    v_fma_f32 v15, -v8, v12, v15
    v_mul_f32 v20, 3298820096, v5
    v_mul_f32 v21, 1151336448, v6
    v_exp_f32 v20, v20
    v_fract_f32 v21, v21
    v_cos_f32 v12, v21
    v_sin_f32 v13, v21
    s_nop 0
    v_mul_f32 v12, v20, v12
    v_mul_f32 v13, -v20, v13
    v_mul_f32 v16, v7, v12
    v_mul_f32 v17, v7, v13
    v_fma_f32 v16, v8, v13, v16
    v_fma_f32 v17, -v8, v12, v17
    v_add_u32 v9, 8448, v23
    v_add_u32 v18, 21120, v23
    v_cvt_pk_bf16_f32 v24, v14, v15
    ds_write_b32 v9, v24 offset:0
    v_cvt_pk_bf16_f32 v25, v16, v17
    ds_write_b32 v18, v25 offset:0
    v_pk_mul_f32 v[26:27], v[14:15], v[10:11] op_sel_hi:[1,0]
    v_pk_fma_f32 v[14:15], v[14:15], v[10:11], v[26:27] op_sel:[1,1,0] op_sel_hi:[0,1,1] neg_lo:[1,0,0]
    v_pk_mul_f32 v[28:29], v[16:17], v[10:11] op_sel_hi:[1,0]
    v_pk_fma_f32 v[16:17], v[16:17], v[10:11], v[28:29] op_sel:[1,1,0] op_sel_hi:[0,1,1] neg_lo:[1,0,0]
    v_cvt_pk_bf16_f32 v24, v14, v15
    ds_write_b32 v9, v24 offset:528
    v_cvt_pk_bf16_f32 v25, v16, v17
    ds_write_b32 v18, v25 offset:528
    v_pk_mul_f32 v[26:27], v[14:15], v[10:11] op_sel_hi:[1,0]
    v_pk_fma_f32 v[14:15], v[14:15], v[10:11], v[26:27] op_sel:[1,1,0] op_sel_hi:[0,1,1] neg_lo:[1,0,0]
    v_pk_mul_f32 v[28:29], v[16:17], v[10:11] op_sel_hi:[1,0]
    v_pk_fma_f32 v[16:17], v[16:17], v[10:11], v[28:29] op_sel:[1,1,0] op_sel_hi:[0,1,1] neg_lo:[1,0,0]
    v_cvt_pk_bf16_f32 v24, v14, v15
    ds_write_b32 v9, v24 offset:1056
    v_cvt_pk_bf16_f32 v25, v16, v17
    ds_write_b32 v18, v25 offset:1056
    v_pk_mul_f32 v[26:27], v[14:15], v[10:11] op_sel_hi:[1,0]
    v_pk_fma_f32 v[14:15], v[14:15], v[10:11], v[26:27] op_sel:[1,1,0] op_sel_hi:[0,1,1] neg_lo:[1,0,0]
    v_pk_mul_f32 v[28:29], v[16:17], v[10:11] op_sel_hi:[1,0]
    v_pk_fma_f32 v[16:17], v[16:17], v[10:11], v[28:29] op_sel:[1,1,0] op_sel_hi:[0,1,1] neg_lo:[1,0,0]
    v_cvt_pk_bf16_f32 v24, v14, v15
    ds_write_b32 v9, v24 offset:1584
    v_cvt_pk_bf16_f32 v25, v16, v17
    ds_write_b32 v18, v25 offset:1584
    v_pk_mul_f32 v[26:27], v[14:15], v[10:11] op_sel_hi:[1,0]
    v_pk_fma_f32 v[14:15], v[14:15], v[10:11], v[26:27] op_sel:[1,1,0] op_sel_hi:[0,1,1] neg_lo:[1,0,0]
    v_pk_mul_f32 v[28:29], v[16:17], v[10:11] op_sel_hi:[1,0]
    v_pk_fma_f32 v[16:17], v[16:17], v[10:11], v[28:29] op_sel:[1,1,0] op_sel_hi:[0,1,1] neg_lo:[1,0,0]
    v_cvt_pk_bf16_f32 v24, v14, v15
    ds_write_b32 v9, v24 offset:2112
    v_cvt_pk_bf16_f32 v25, v16, v17
    ds_write_b32 v18, v25 offset:2112
    v_pk_mul_f32 v[26:27], v[14:15], v[10:11] op_sel_hi:[1,0]
    v_pk_fma_f32 v[14:15], v[14:15], v[10:11], v[26:27] op_sel:[1,1,0] op_sel_hi:[0,1,1] neg_lo:[1,0,0]
    v_pk_mul_f32 v[28:29], v[16:17], v[10:11] op_sel_hi:[1,0]
    v_pk_fma_f32 v[16:17], v[16:17], v[10:11], v[28:29] op_sel:[1,1,0] op_sel_hi:[0,1,1] neg_lo:[1,0,0]
    v_cvt_pk_bf16_f32 v24, v14, v15
    ds_write_b32 v9, v24 offset:2640
    v_cvt_pk_bf16_f32 v25, v16, v17
    ds_write_b32 v18, v25 offset:2640
    v_pk_mul_f32 v[26:27], v[14:15], v[10:11] op_sel_hi:[1,0]
    v_pk_fma_f32 v[14:15], v[14:15], v[10:11], v[26:27] op_sel:[1,1,0] op_sel_hi:[0,1,1] neg_lo:[1,0,0]
    v_pk_mul_f32 v[28:29], v[16:17], v[10:11] op_sel_hi:[1,0]
    v_pk_fma_f32 v[16:17], v[16:17], v[10:11], v[28:29] op_sel:[1,1,0] op_sel_hi:[0,1,1] neg_lo:[1,0,0]
    v_cvt_pk_bf16_f32 v24, v14, v15
    ds_write_b32 v9, v24 offset:3168
    v_cvt_pk_bf16_f32 v25, v16, v17
    ds_write_b32 v18, v25 offset:3168
    v_pk_mul_f32 v[26:27], v[14:15], v[10:11] op_sel_hi:[1,0]
    v_pk_fma_f32 v[14:15], v[14:15], v[10:11], v[26:27] op_sel:[1,1,0] op_sel_hi:[0,1,1] neg_lo:[1,0,0]
    v_pk_mul_f32 v[28:29], v[16:17], v[10:11] op_sel_hi:[1,0]
    v_pk_fma_f32 v[16:17], v[16:17], v[10:11], v[28:29] op_sel:[1,1,0] op_sel_hi:[0,1,1] neg_lo:[1,0,0]
    v_cvt_pk_bf16_f32 v24, v14, v15
    ds_write_b32 v9, v24 offset:3696
    v_cvt_pk_bf16_f32 v25, v16, v17
    ds_write_b32 v18, v25 offset:3696
    v_pk_mul_f32 v[26:27], v[14:15], v[10:11] op_sel_hi:[1,0]
    v_pk_fma_f32 v[14:15], v[14:15], v[10:11], v[26:27] op_sel:[1,1,0] op_sel_hi:[0,1,1] neg_lo:[1,0,0]
    v_pk_mul_f32 v[28:29], v[16:17], v[10:11] op_sel_hi:[1,0]
    v_pk_fma_f32 v[16:17], v[16:17], v[10:11], v[28:29] op_sel:[1,1,0] op_sel_hi:[0,1,1] neg_lo:[1,0,0]
    v_cvt_pk_bf16_f32 v24, v14, v15
    ds_write_b32 v9, v24 offset:4224
    v_cvt_pk_bf16_f32 v25, v16, v17
    ds_write_b32 v18, v25 offset:4224
    v_pk_mul_f32 v[26:27], v[14:15], v[10:11] op_sel_hi:[1,0]
    v_pk_fma_f32 v[14:15], v[14:15], v[10:11], v[26:27] op_sel:[1,1,0] op_sel_hi:[0,1,1] neg_lo:[1,0,0]
    v_pk_mul_f32 v[28:29], v[16:17], v[10:11] op_sel_hi:[1,0]
    v_pk_fma_f32 v[16:17], v[16:17], v[10:11], v[28:29] op_sel:[1,1,0] op_sel_hi:[0,1,1] neg_lo:[1,0,0]
    v_cvt_pk_bf16_f32 v24, v14, v15
    ds_write_b32 v9, v24 offset:4752
    v_cvt_pk_bf16_f32 v25, v16, v17
    ds_write_b32 v18, v25 offset:4752
    v_pk_mul_f32 v[26:27], v[14:15], v[10:11] op_sel_hi:[1,0]
    v_pk_fma_f32 v[14:15], v[14:15], v[10:11], v[26:27] op_sel:[1,1,0] op_sel_hi:[0,1,1] neg_lo:[1,0,0]
    v_pk_mul_f32 v[28:29], v[16:17], v[10:11] op_sel_hi:[1,0]
    v_pk_fma_f32 v[16:17], v[16:17], v[10:11], v[28:29] op_sel:[1,1,0] op_sel_hi:[0,1,1] neg_lo:[1,0,0]
    v_cvt_pk_bf16_f32 v24, v14, v15
    ds_write_b32 v9, v24 offset:5280
    v_cvt_pk_bf16_f32 v25, v16, v17
    ds_write_b32 v18, v25 offset:5280
    v_pk_mul_f32 v[26:27], v[14:15], v[10:11] op_sel_hi:[1,0]
    v_pk_fma_f32 v[14:15], v[14:15], v[10:11], v[26:27] op_sel:[1,1,0] op_sel_hi:[0,1,1] neg_lo:[1,0,0]
    v_pk_mul_f32 v[28:29], v[16:17], v[10:11] op_sel_hi:[1,0]
    v_pk_fma_f32 v[16:17], v[16:17], v[10:11], v[28:29] op_sel:[1,1,0] op_sel_hi:[0,1,1] neg_lo:[1,0,0]
    v_cvt_pk_bf16_f32 v24, v14, v15
    ds_write_b32 v9, v24 offset:5808
    v_cvt_pk_bf16_f32 v25, v16, v17
    ds_write_b32 v18, v25 offset:5808
    v_pk_mul_f32 v[26:27], v[14:15], v[10:11] op_sel_hi:[1,0]
    v_pk_fma_f32 v[14:15], v[14:15], v[10:11], v[26:27] op_sel:[1,1,0] op_sel_hi:[0,1,1] neg_lo:[1,0,0]
    v_pk_mul_f32 v[28:29], v[16:17], v[10:11] op_sel_hi:[1,0]
    v_pk_fma_f32 v[16:17], v[16:17], v[10:11], v[28:29] op_sel:[1,1,0] op_sel_hi:[0,1,1] neg_lo:[1,0,0]
    v_cvt_pk_bf16_f32 v24, v14, v15
    ds_write_b32 v9, v24 offset:6336
    v_cvt_pk_bf16_f32 v25, v16, v17
    ds_write_b32 v18, v25 offset:6336
    v_pk_mul_f32 v[26:27], v[14:15], v[10:11] op_sel_hi:[1,0]
    v_pk_fma_f32 v[14:15], v[14:15], v[10:11], v[26:27] op_sel:[1,1,0] op_sel_hi:[0,1,1] neg_lo:[1,0,0]
    v_pk_mul_f32 v[28:29], v[16:17], v[10:11] op_sel_hi:[1,0]
    v_pk_fma_f32 v[16:17], v[16:17], v[10:11], v[28:29] op_sel:[1,1,0] op_sel_hi:[0,1,1] neg_lo:[1,0,0]
    v_cvt_pk_bf16_f32 v24, v14, v15
    ds_write_b32 v9, v24 offset:6864
    v_cvt_pk_bf16_f32 v25, v16, v17
    ds_write_b32 v18, v25 offset:6864
    v_pk_mul_f32 v[26:27], v[14:15], v[10:11] op_sel_hi:[1,0]
    v_pk_fma_f32 v[14:15], v[14:15], v[10:11], v[26:27] op_sel:[1,1,0] op_sel_hi:[0,1,1] neg_lo:[1,0,0]
    v_pk_mul_f32 v[28:29], v[16:17], v[10:11] op_sel_hi:[1,0]
    v_pk_fma_f32 v[16:17], v[16:17], v[10:11], v[28:29] op_sel:[1,1,0] op_sel_hi:[0,1,1] neg_lo:[1,0,0]
    v_cvt_pk_bf16_f32 v24, v14, v15
    ds_write_b32 v9, v24 offset:7392
    v_cvt_pk_bf16_f32 v25, v16, v17
    ds_write_b32 v18, v25 offset:7392
    v_pk_mul_f32 v[26:27], v[14:15], v[10:11] op_sel_hi:[1,0]
    v_pk_fma_f32 v[14:15], v[14:15], v[10:11], v[26:27] op_sel:[1,1,0] op_sel_hi:[0,1,1] neg_lo:[1,0,0]
    v_pk_mul_f32 v[28:29], v[16:17], v[10:11] op_sel_hi:[1,0]
    v_pk_fma_f32 v[16:17], v[16:17], v[10:11], v[28:29] op_sel:[1,1,0] op_sel_hi:[0,1,1] neg_lo:[1,0,0]
    v_cvt_pk_bf16_f32 v24, v14, v15
    ds_write_b32 v9, v24 offset:7920
    v_cvt_pk_bf16_f32 v25, v16, v17
    ds_write_b32 v18, v25 offset:7920
    v_pk_mul_f32 v[26:27], v[14:15], v[10:11] op_sel_hi:[1,0]
    v_pk_fma_f32 v[14:15], v[14:15], v[10:11], v[26:27] op_sel:[1,1,0] op_sel_hi:[0,1,1] neg_lo:[1,0,0]
    v_pk_mul_f32 v[28:29], v[16:17], v[10:11] op_sel_hi:[1,0]
    v_pk_fma_f32 v[16:17], v[16:17], v[10:11], v[28:29] op_sel:[1,1,0] op_sel_hi:[0,1,1] neg_lo:[1,0,0]
    v_cvt_pk_bf16_f32 v24, v14, v15
    ds_write_b32 v9, v24 offset:8448
    v_cvt_pk_bf16_f32 v25, v16, v17
    ds_write_b32 v18, v25 offset:8448
    v_pk_mul_f32 v[26:27], v[14:15], v[10:11] op_sel_hi:[1,0]
    v_pk_fma_f32 v[14:15], v[14:15], v[10:11], v[26:27] op_sel:[1,1,0] op_sel_hi:[0,1,1] neg_lo:[1,0,0]
    v_pk_mul_f32 v[28:29], v[16:17], v[10:11] op_sel_hi:[1,0]
    v_pk_fma_f32 v[16:17], v[16:17], v[10:11], v[28:29] op_sel:[1,1,0] op_sel_hi:[0,1,1] neg_lo:[1,0,0]
    v_cvt_pk_bf16_f32 v24, v14, v15
    ds_write_b32 v9, v24 offset:8976
    v_cvt_pk_bf16_f32 v25, v16, v17
    ds_write_b32 v18, v25 offset:8976
    v_pk_mul_f32 v[26:27], v[14:15], v[10:11] op_sel_hi:[1,0]
    v_pk_fma_f32 v[14:15], v[14:15], v[10:11], v[26:27] op_sel:[1,1,0] op_sel_hi:[0,1,1] neg_lo:[1,0,0]
    v_pk_mul_f32 v[28:29], v[16:17], v[10:11] op_sel_hi:[1,0]
    v_pk_fma_f32 v[16:17], v[16:17], v[10:11], v[28:29] op_sel:[1,1,0] op_sel_hi:[0,1,1] neg_lo:[1,0,0]
    v_cvt_pk_bf16_f32 v24, v14, v15
    ds_write_b32 v9, v24 offset:9504
    v_cvt_pk_bf16_f32 v25, v16, v17
    ds_write_b32 v18, v25 offset:9504
    v_pk_mul_f32 v[26:27], v[14:15], v[10:11] op_sel_hi:[1,0]
    v_pk_fma_f32 v[14:15], v[14:15], v[10:11], v[26:27] op_sel:[1,1,0] op_sel_hi:[0,1,1] neg_lo:[1,0,0]
    v_pk_mul_f32 v[28:29], v[16:17], v[10:11] op_sel_hi:[1,0]
    v_pk_fma_f32 v[16:17], v[16:17], v[10:11], v[28:29] op_sel:[1,1,0] op_sel_hi:[0,1,1] neg_lo:[1,0,0]
    v_cvt_pk_bf16_f32 v24, v14, v15
    ds_write_b32 v9, v24 offset:10032
    v_cvt_pk_bf16_f32 v25, v16, v17
    ds_write_b32 v18, v25 offset:10032
    v_pk_mul_f32 v[26:27], v[14:15], v[10:11] op_sel_hi:[1,0]
    v_pk_fma_f32 v[14:15], v[14:15], v[10:11], v[26:27] op_sel:[1,1,0] op_sel_hi:[0,1,1] neg_lo:[1,0,0]
    v_pk_mul_f32 v[28:29], v[16:17], v[10:11] op_sel_hi:[1,0]
    v_pk_fma_f32 v[16:17], v[16:17], v[10:11], v[28:29] op_sel:[1,1,0] op_sel_hi:[0,1,1] neg_lo:[1,0,0]
    v_cvt_pk_bf16_f32 v24, v14, v15
    ds_write_b32 v9, v24 offset:10560
    v_cvt_pk_bf16_f32 v25, v16, v17
    ds_write_b32 v18, v25 offset:10560
    v_pk_mul_f32 v[26:27], v[14:15], v[10:11] op_sel_hi:[1,0]
    v_pk_fma_f32 v[14:15], v[14:15], v[10:11], v[26:27] op_sel:[1,1,0] op_sel_hi:[0,1,1] neg_lo:[1,0,0]
    v_pk_mul_f32 v[28:29], v[16:17], v[10:11] op_sel_hi:[1,0]
    v_pk_fma_f32 v[16:17], v[16:17], v[10:11], v[28:29] op_sel:[1,1,0] op_sel_hi:[0,1,1] neg_lo:[1,0,0]
    v_cvt_pk_bf16_f32 v24, v14, v15
    ds_write_b32 v9, v24 offset:11088
    v_cvt_pk_bf16_f32 v25, v16, v17
    ds_write_b32 v18, v25 offset:11088
    v_pk_mul_f32 v[26:27], v[14:15], v[10:11] op_sel_hi:[1,0]
    v_pk_fma_f32 v[14:15], v[14:15], v[10:11], v[26:27] op_sel:[1,1,0] op_sel_hi:[0,1,1] neg_lo:[1,0,0]
    v_pk_mul_f32 v[28:29], v[16:17], v[10:11] op_sel_hi:[1,0]
    v_pk_fma_f32 v[16:17], v[16:17], v[10:11], v[28:29] op_sel:[1,1,0] op_sel_hi:[0,1,1] neg_lo:[1,0,0]
    v_cvt_pk_bf16_f32 v24, v14, v15
    ds_write_b32 v9, v24 offset:11616
    v_cvt_pk_bf16_f32 v25, v16, v17
    ds_write_b32 v18, v25 offset:11616
    v_pk_mul_f32 v[26:27], v[14:15], v[10:11] op_sel_hi:[1,0]
    v_pk_fma_f32 v[14:15], v[14:15], v[10:11], v[26:27] op_sel:[1,1,0] op_sel_hi:[0,1,1] neg_lo:[1,0,0]
    v_pk_mul_f32 v[28:29], v[16:17], v[10:11] op_sel_hi:[1,0]
    v_pk_fma_f32 v[16:17], v[16:17], v[10:11], v[28:29] op_sel:[1,1,0] op_sel_hi:[0,1,1] neg_lo:[1,0,0]
    v_cvt_pk_bf16_f32 v24, v14, v15
    ds_write_b32 v9, v24 offset:12144
    v_cvt_pk_bf16_f32 v25, v16, v17
    ds_write_b32 v18, v25 offset:12144
K1_KG_J_1:
    s_waitcnt lgkmcnt(0)
    s_barrier
    v_lshrrev_b32 v3, 5, v1
    v_and_b32 v19, 31, v1
    s_movk_i32 s3, 528
    v_and_b32 v20, 1, v2
    v_lshl_add_u32 v20, v20, 5, v19
    v_mul_lo_u32 v20, v20, s3
    v_lshl_add_u32 v20, v3, 4, v20
    s_lshl_b32 s23, s22, 8
    v_add_u32 v20, s23, v20
    v_mul_lo_u32 v21, v19, s3
    v_lshl_add_u32 v21, v3, 4, v21
    v_add_u32 v21, s23, v21
    v_add_u32 v21, 33792, v21
    ds_read_b128 v[48:51], v20 offset:0
    ds_read_b128 v[80:83], v21 offset:0
    ds_read_b128 v[52:55], v20 offset:32
    ds_read_b128 v[84:87], v21 offset:32
    ds_read_b128 v[56:59], v20 offset:64
    ds_read_b128 v[88:91], v21 offset:64
    ds_read_b128 v[60:63], v20 offset:96
    ds_read_b128 v[92:95], v21 offset:96
    ds_read_b128 v[64:67], v20 offset:128
    ds_read_b128 v[96:99], v21 offset:128
    ds_read_b128 v[68:71], v20 offset:160
    ds_read_b128 v[100:103], v21 offset:160
    ds_read_b128 v[72:75], v20 offset:192
    ds_read_b128 v[104:107], v21 offset:192
    ds_read_b128 v[76:79], v20 offset:224
    ds_read_b128 v[108:111], v21 offset:224
    s_waitcnt lgkmcnt(14)
    v_mfma_f32_32x32x16_bf16 v[32:47], v[48:51], v[80:83], 0
    s_waitcnt lgkmcnt(12)
    v_mfma_f32_32x32x16_bf16 v[32:47], v[52:55], v[84:87], v[32:47]
    s_waitcnt lgkmcnt(10)
    v_mfma_f32_32x32x16_bf16 v[32:47], v[56:59], v[88:91], v[32:47]
    s_waitcnt lgkmcnt(8)
    v_mfma_f32_32x32x16_bf16 v[32:47], v[60:63], v[92:95], v[32:47]
    s_waitcnt lgkmcnt(6)
    v_mfma_f32_32x32x16_bf16 v[32:47], v[64:67], v[96:99], v[32:47]
    s_waitcnt lgkmcnt(4)
    v_mfma_f32_32x32x16_bf16 v[32:47], v[68:71], v[100:103], v[32:47]
    s_waitcnt lgkmcnt(2)
    v_mfma_f32_32x32x16_bf16 v[32:47], v[72:75], v[104:107], v[32:47]
    s_waitcnt lgkmcnt(0)
    v_mfma_f32_32x32x16_bf16 v[32:47], v[76:79], v[108:111], v[32:47]
    s_barrier
    s_mul_i32 s24, s22, 8208
    v_lshlrev_b32 v20, 9, v3
    v_lshl_add_u32 v20, v19, 2, v20
    v_add_u32 v20, s24, v20
    s_and_b32 s25, s89, 1
    s_lshl_b32 s25, s25, 12
    v_add_u32 v20, s25, v20
    s_nop 7
    ds_write_b32 v20, v32 offset:4
    ds_write_b32 v20, v33 offset:132
    ds_write_b32 v20, v34 offset:260
    ds_write_b32 v20, v35 offset:388
    ds_write_b32 v20, v36 offset:1028
    ds_write_b32 v20, v37 offset:1156
    ds_write_b32 v20, v38 offset:1284
    ds_write_b32 v20, v39 offset:1412
    ds_write_b32 v20, v40 offset:2052
    ds_write_b32 v20, v41 offset:2180
    ds_write_b32 v20, v42 offset:2308
    ds_write_b32 v20, v43 offset:2436
    ds_write_b32 v20, v44 offset:3076
    ds_write_b32 v20, v45 offset:3204
    ds_write_b32 v20, v46 offset:3332
    ds_write_b32 v20, v47 offset:3460
    s_cmp_eq_u32 s22, 0
    s_cbranch_scc0 K1_KG_NS_1
    v_mov_b32 v22, v7
    s_nop 1
    v_add_f32_dpp v22, v22, v22 row_ror:1 row_mask:0xf bank_mask:0xf
    s_nop 1
    v_add_f32_dpp v22, v22, v22 row_ror:2 row_mask:0xf bank_mask:0xf
    s_nop 1
    v_add_f32_dpp v22, v22, v22 row_ror:4 row_mask:0xf bank_mask:0xf
    s_nop 1
    v_add_f32_dpp v22, v22, v22 row_ror:8 row_mask:0xf bank_mask:0xf
    s_nop 1
    v_readlane_b32 s26, v22, 0
    v_readlane_b32 s27, v22, 16
    v_readlane_b32 s28, v22, 32
    v_readlane_b32 s29, v22, 48
    s_nop 1
    v_mov_b32 v22, s26
    v_add_f32 v22, s27, v22
    v_add_f32 v22, s28, v22
    v_add_f32 v22, s29, v22
    s_and_b32 s25, s89, 1
    s_mul_i32 s25, s25, 8208
    v_mov_b32 v23, s25
    ds_write_b32 v23, v22
K1_KG_NS_1:
    s_waitcnt lgkmcnt(0)
    s_barrier
    v_lshlrev_b32 v20, 3, v0
    v_sub_u32 v21, 2047, v20
    v_subrev_u32 v24, 0, v21
    v_subrev_u32 v25, 1, v21
    v_subrev_u32 v26, 2, v21
    v_subrev_u32 v27, 3, v21
    v_subrev_u32 v28, 4, v21
    v_subrev_u32 v29, 5, v21
    v_subrev_u32 v30, 6, v21
    v_subrev_u32 v31, 7, v21
    v_subrev_u32 v32, 8, v21
    v_cmp_gt_i32 vcc, 0, v32
    v_max_i32 v32, 0, v32
    v_cvt_f32_u32 v24, v24
    v_cvt_f32_u32 v25, v25
    v_cvt_f32_u32 v26, v26
    v_cvt_f32_u32 v27, v27
    v_cvt_f32_u32 v28, v28
    v_cvt_f32_u32 v29, v29
    v_cvt_f32_u32 v30, v30
    v_cvt_f32_u32 v31, v31
    v_cvt_f32_u32 v32, v32
    v_bfe_u32 v22, v24, 16, 1
    v_add3_u32 v24, v24, v22, s90
    v_and_b32 v24, 0xffff0000, v24
    v_bfe_u32 v22, v25, 16, 1
    v_add3_u32 v25, v25, v22, s90
    v_and_b32 v25, 0xffff0000, v25
    v_bfe_u32 v22, v26, 16, 1
    v_add3_u32 v26, v26, v22, s90
    v_and_b32 v26, 0xffff0000, v26
    v_bfe_u32 v22, v27, 16, 1
    v_add3_u32 v27, v27, v22, s90
    v_and_b32 v27, 0xffff0000, v27
    v_bfe_u32 v22, v28, 16, 1
    v_add3_u32 v28, v28, v22, s90
    v_and_b32 v28, 0xffff0000, v28
    v_bfe_u32 v22, v29, 16, 1
    v_add3_u32 v29, v29, v22, s90
    v_and_b32 v29, 0xffff0000, v29
    v_bfe_u32 v22, v30, 16, 1
    v_add3_u32 v30, v30, v22, s90
    v_and_b32 v30, 0xffff0000, v30
    v_bfe_u32 v22, v31, 16, 1
    v_add3_u32 v31, v31, v22, s90
    v_and_b32 v31, 0xffff0000, v31
    v_bfe_u32 v22, v32, 16, 1
    v_add3_u32 v32, v32, v22, s90
    v_and_b32 v32, 0xffff0000, v32
    v_cvt_u32_f32 v24, v24
    v_lshlrev_b32 v24, 2, v24
    v_cvt_u32_f32 v25, v25
    v_lshlrev_b32 v25, 2, v25
    v_cvt_u32_f32 v26, v26
    v_lshlrev_b32 v26, 2, v26
    v_cvt_u32_f32 v27, v27
    v_lshlrev_b32 v27, 2, v27
    v_cvt_u32_f32 v28, v28
    v_lshlrev_b32 v28, 2, v28
    v_cvt_u32_f32 v29, v29
    v_lshlrev_b32 v29, 2, v29
    v_cvt_u32_f32 v30, v30
    v_lshlrev_b32 v30, 2, v30
    v_cvt_u32_f32 v31, v31
    v_lshlrev_b32 v31, 2, v31
    v_cvt_u32_f32 v32, v32
    v_lshlrev_b32 v32, 2, v32
    ds_read_b32 v40, v24
    ds_read_b32 v41, v24 offset:8208
    ds_read_b32 v42, v25
    ds_read_b32 v43, v25 offset:8208
    ds_read_b32 v44, v26
    ds_read_b32 v45, v26 offset:8208
    ds_read_b32 v46, v27
    ds_read_b32 v47, v27 offset:8208
    ds_read_b32 v48, v28
    ds_read_b32 v49, v28 offset:8208
    ds_read_b32 v50, v29
    ds_read_b32 v51, v29 offset:8208
    ds_read_b32 v52, v30
    ds_read_b32 v53, v30 offset:8208
    ds_read_b32 v54, v31
    ds_read_b32 v55, v31 offset:8208
    ds_read_b32 v56, v32
    ds_read_b32 v57, v32 offset:8208
    s_waitcnt lgkmcnt(0)
    v_add_f32 v40, v40, v41
    v_add_f32 v42, v42, v43
    v_add_f32 v44, v44, v45
    v_add_f32 v46, v46, v47
    v_add_f32 v48, v48, v49
    v_add_f32 v50, v50, v51
    v_add_f32 v52, v52, v53
    v_add_f32 v54, v54, v55
    v_add_f32 v56, v56, v57
    v_cndmask_b32 v56, v56, 0, vcc
    v_cvt_pk_bf16_f32 v60, v40, v42
    v_cvt_pk_bf16_f32 v64, v42, v44
    v_cvt_pk_bf16_f32 v61, v44, v46
    v_cvt_pk_bf16_f32 v65, v46, v48
    v_cvt_pk_bf16_f32 v62, v48, v50
    v_cvt_pk_bf16_f32 v66, v50, v52
    v_cvt_pk_bf16_f32 v63, v52, v54
    v_cvt_pk_bf16_f32 v67, v54, v56
    v_mov_b32 v144, v60
    v_mov_b32 v145, v61
    v_mov_b32 v146, v62
    v_mov_b32 v147, v63
    v_mov_b32 v148, v64
    v_mov_b32 v149, v65
    v_mov_b32 v150, v66
    v_mov_b32 v151, v67
    s_barrier
    s_add_u32 s16, s6, 4890624
    s_addc_u32 s17, s7, 0
    s_mul_i32 s3, s30, 8448
    v_lshlrev_b32 v21, 4, v0
    v_add_u32 v21, s3, v21
    global_store_dwordx4 v21, v[136:139], s[16:17]
    v_add_u32 v22, 4224, v21
    global_store_dwordx4 v22, v[140:143], s[16:17]
    v_add_u32 v21, 8448, v21
    global_store_dwordx4 v21, v[144:147], s[16:17]
    v_add_u32 v22, 4224, v21
    global_store_dwordx4 v22, v[148:151], s[16:17]
    v_add_u32 v21, 8448, v21
    v_cmp_gt_u32 vcc, 32, v0
    s_and_saveexec_b64 s[32:33], vcc
    s_cbranch_execz K1_KG_E
    v_mov_b32 v68, 0
    v_mov_b32 v69, 0
    v_mov_b32 v70, 0
    v_mov_b32 v71, 0
    v_lshrrev_b32 v21, 3, v0
    v_mul_u32_u24 v21, 4224, v21
    v_and_b32 v22, 7, v0
    v_lshl_add_u32 v21, v22, 4, v21
    v_add_u32 v21, s3, v21
    v_add_u32 v21, 4096, v21
    global_store_dwordx4 v21, v[68:71], s[16:17]
K1_KG_E:
    s_mov_b64 exec, -1
    s_endpgm
.text
.globl attn_kernel
.p2align 8
.type attn_kernel,@function
attn_kernel:
    s_movk_i32 s90, 0x7fff
    s_cmp_ge_u32 s2, 256
    s_cbranch_scc1 K2_END
    s_load_dwordx2 s[6:7], s[0:1], 120
    s_load_dwordx2 s[4:5], s[0:1], 0
    v_lshrrev_b32 v1, 6, v0
    s_nop 0
    v_readfirstlane_b32 s3, v1
    s_nop 3
    s_cmp_ge_u32 s3, 8
    s_cbranch_scc1 K2_CONV
    s_setprio 3
    v_and_b32 v1, 63, v0
    v_lshrrev_b32 v2, 5, v1
    v_and_b32 v3, 31, v1
    s_waitcnt lgkmcnt(0)
    s_add_u32 s8, s6, 4718592
    s_addc_u32 s9, s7, 0
    s_add_u32 s10, s6, 0
    s_addc_u32 s11, s7, 0
    s_add_u32 s12, s6, 2359296
    s_addc_u32 s13, s7, 0
    v_lshlrev_b32 v7, 4, v0
    v_mov_b32 v8, v7
    v_add_u32 v14, 65536, v7
    global_load_dwordx4 v[112:115], v8, s[8:9]
    v_add_u32 v8, 8192, v8
    global_load_dwordx4 v[116:119], v8, s[8:9]
    v_add_u32 v8, 8192, v8
    global_load_dwordx4 v[120:123], v8, s[8:9]
    v_add_u32 v8, 8192, v8
    global_load_dwordx4 v[124:127], v8, s[8:9]
    v_add_u32 v8, 8192, v8
    global_load_dwordx4 v[128:131], v8, s[8:9]
    v_add_u32 v8, 8192, v8
    global_load_dwordx4 v[132:135], v8, s[8:9]
    v_add_u32 v8, 8192, v8
    global_load_dwordx4 v[136:139], v8, s[8:9]
    v_add_u32 v8, 8192, v8
    global_load_dwordx4 v[140:143], v8, s[8:9]
    v_add_u32 v8, 8192, v8
    global_load_dwordx4 v[144:147], v8, s[8:9]
    v_add_u32 v8, 8192, v8
    s_cmp_lt_u32 s3, 4
    s_cbranch_scc0 K2_SL0
    global_load_dwordx4 v[148:151], v8, s[8:9]
K2_SL0:
    v_add_u32 v8, 8192, v8
    s_lshl_b32 s14, s2, 3
    s_add_u32 s14, s14, s3
    s_mul_i32 s14, s14, 1152
    v_mul_u32_u24 v11, 36, v3
    v_add_u32 v11, s14, v11
    v_lshl_add_u32 v12, v2, 4, v11
    global_load_dwordx4 v[16:19], v12, s[10:11]
    global_load_dword v20, v11, s[10:11] offset:32
    v_mov_b32 v158, v11
    s_add_u32 s24, s6, 14483456
    s_addc_u32 s25, s7, 0
    v_lshlrev_b32 v11, 2, v1
    global_load_dword v152, v11, s[24:25]
    v_mov_b32 v21, 0
    v_mov_b32 v22, 0
    v_mov_b32 v23, 0
    s_mov_b32 s16, -1
    s_mov_b32 s17, 0
    s_mov_b32 s18, 0x3ffff
    s_mov_b32 s19, 0x3ffff
    v_lshlrev_b32 v4, 4, v1
    v_lshlrev_b32 v5, 3, v3
    v_add_u32 v5, 32768, v5
    v_mul_u32_u24 v6, 18, v2
    v_add_u32 v6, v3, v6
    v_lshlrev_b32 v6, 4, v6
    v_add_u32 v6, 40960, v6
    v_cmp_eq_u32 vcc, 0, v2
    v_mov_b32 v11, 147344
    v_mov_b32 v12, 512
    s_nop 0
    v_cndmask_b32 v5, v11, v5, vcc
    v_cndmask_b32 v154, 0, v12, vcc
    v_cmp_eq_u32 vcc, 18, v3
    v_mov_b32 v12, 150256
    s_nop 1
    v_cndmask_b32 v11, v11, v12, vcc
    v_cmp_gt_u32 vcc, 18, v3
    v_mov_b32 v12, 2304
    s_nop 1
    v_cndmask_b32 v6, v11, v6, vcc
    v_cndmask_b32 v155, 0, v12, vcc
    v_mov_b32 v156, v5
    v_mov_b32 v157, v6
    v_and_b32 v11, 255, v0
    v_lshrrev_b32 v12, 8, v0
    v_mul_u32_u24 v13, 2912, v12
    v_lshl_add_u32 v13, v11, 4, v13
    v_add_u32 v13, 147344, v13
    v_mul_u32_u24 v12, 0x3f80, v12
    v_lshl_or_b32 v64, v12, 16, v12
    v_mov_b32 v65, v64
    v_mov_b32 v66, v64
    v_mov_b32 v67, v64
    v_cmp_gt_u32 vcc, 182, v11
    s_and_saveexec_b64 s[28:29], vcc
    ds_write_b128 v13, v[64:67]
    s_mov_b64 exec, s[28:29]
    v_mov_b32 v88, 0
    v_mov_b32 v89, 0
    v_mov_b32 v90, 0
    v_mov_b32 v91, 0
    v_mov_b32 v92, 0
    v_mov_b32 v93, 0
    v_mov_b32 v94, 0
    v_mov_b32 v95, 0
    v_cmp_eq_u32 vcc, 18, v3
    v_mov_b32 v11, 0x3f803f80
    s_nop 1
    v_cndmask_b32 v11, 0, v11, vcc
    v_mov_b32 v96, v11
    v_mov_b32 v97, v11
    v_mov_b32 v98, v11
    v_mov_b32 v99, v11
    v_mov_b32 v100, v11
    v_mov_b32 v101, v11
    v_mov_b32 v102, v11
    v_mov_b32 v103, v11
    v_mov_b32 v104, v11
    v_mov_b32 v105, v11
    v_mov_b32 v106, v11
    v_mov_b32 v107, v11
    v_mov_b32 v108, v11
    v_mov_b32 v109, v11
    v_mov_b32 v110, v11
    v_mov_b32 v111, v11
    v_mov_b32 v64, 0
    v_mov_b32 v65, 0
    v_mov_b32 v66, 0
    v_mov_b32 v67, 0
    v_mov_b32 v68, 0
    v_mov_b32 v69, 0
    v_mov_b32 v70, 0
    v_mov_b32 v71, 0
    v_mov_b32 v72, 0
    v_mov_b32 v73, 0
    v_mov_b32 v74, 0
    v_mov_b32 v75, 0
    v_mov_b32 v76, 0
    v_mov_b32 v77, 0
    v_mov_b32 v78, 0
    v_mov_b32 v79, 0
    v_mov_b32 v9, 0
    s_mov_b32 s20, 0xff7fffff
    s_waitcnt vmcnt(0)
    ds_write_b128 v7, v[112:115] offset:0
    ds_write_b128 v7, v[116:119] offset:8192
    ds_write_b128 v7, v[120:123] offset:16384
    ds_write_b128 v7, v[124:127] offset:24576
    ds_write_b128 v7, v[128:131] offset:32768
    ds_write_b128 v7, v[132:135] offset:40960
    ds_write_b128 v7, v[136:139] offset:49152
    ds_write_b128 v7, v[140:143] offset:57344
    ds_write_b128 v14, v[144:147] offset:0
    s_cmp_lt_u32 s3, 4
    s_cbranch_scc0 K2_SW0
    ds_write_b128 v14, v[148:151] offset:8192
K2_SW0:
    v_mov_b32 v15, 147328
    v_mov_b32 v11, 0
    ds_write_b32 v15, v11
    v_cmp_eq_u32 vcc, 0, v2
    s_nop 1
    v_cndmask_b32 v20, 0, v20, vcc
    s_nop 1
    v_max_f32_dpp v152, v152, v152 row_ror:1 row_mask:0xf bank_mask:0xf
    s_nop 1
    v_max_f32_dpp v152, v152, v152 row_ror:2 row_mask:0xf bank_mask:0xf
    s_nop 1
    v_max_f32_dpp v152, v152, v152 row_ror:4 row_mask:0xf bank_mask:0xf
    s_nop 1
    v_max_f32_dpp v152, v152, v152 row_ror:8 row_mask:0xf bank_mask:0xf
    s_nop 1
    v_readlane_b32 s26, v152, 0
    v_readlane_b32 s27, v152, 16
    v_readlane_b32 s28, v152, 32
    v_readlane_b32 s29, v152, 48
    s_nop 1
    v_mov_b32 v152, s26
    v_max_f32 v152, s27, v152
    v_max_f32 v152, s28, v152
    v_max_f32 v152, s29, v152
    v_mov_b32 v153, 0
    v_lshlrev_b32 v11, 16, v16
    v_and_b32 v12, 0xffff0000, v16
    v_add_f32 v153, abs(v11), v153
    v_add_f32 v153, abs(v12), v153
    v_lshlrev_b32 v11, 16, v17
    v_and_b32 v12, 0xffff0000, v17
    v_add_f32 v153, abs(v11), v153
    v_add_f32 v153, abs(v12), v153
    v_lshlrev_b32 v11, 16, v18
    v_and_b32 v12, 0xffff0000, v18
    v_add_f32 v153, abs(v11), v153
    v_add_f32 v153, abs(v12), v153
    v_lshlrev_b32 v11, 16, v19
    v_and_b32 v12, 0xffff0000, v19
    v_add_f32 v153, abs(v11), v153
    v_add_f32 v153, abs(v12), v153
    v_lshlrev_b32 v11, 16, v20
    v_and_b32 v12, 0xffff0000, v20
    v_add_f32 v153, abs(v11), v153
    v_add_f32 v153, abs(v12), v153
    v_mov_b32 v11, v153
    v_mov_b32 v12, v153
    s_nop 1
    v_permlane32_swap_b32 v11, v12
    s_nop 1
    v_add_f32 v11, v11, v12
    v_mul_f32 v152, v152, v11
    v_mul_f32 v152, 0x3f840000, v152
    s_waitcnt lgkmcnt(0)
    s_barrier
    global_load_dwordx4 v[112:115], v8, s[8:9]
    v_add_u32 v8, 8192, v8
    global_load_dwordx4 v[116:119], v8, s[8:9]
    v_add_u32 v8, 8192, v8
    global_load_dwordx4 v[120:123], v8, s[8:9]
    v_add_u32 v8, 8192, v8
    global_load_dwordx4 v[124:127], v8, s[8:9]
    v_add_u32 v8, 8192, v8
    global_load_dwordx4 v[128:131], v8, s[8:9]
    v_add_u32 v8, 8192, v8
    global_load_dwordx4 v[132:135], v8, s[8:9]
    v_add_u32 v8, 8192, v8
    global_load_dwordx4 v[136:139], v8, s[8:9]
    v_add_u32 v8, 8192, v8
    global_load_dwordx4 v[140:143], v8, s[8:9]
    v_add_u32 v8, 8192, v8
    global_load_dwordx4 v[144:147], v8, s[8:9]
    v_add_u32 v8, 8192, v8
    s_cmp_lt_u32 s3, 4
    s_cbranch_scc0 K2_SL1
    global_load_dwordx4 v[148:151], v8, s[8:9]
K2_SL1:
    v_add_u32 v8, 8192, v8
    s_mov_b32 s23, 0
    ds_read_b128 v[80:83], v4 offset:0
    ds_read_b64 v[88:89], v5 offset:0
    ds_read_b128 v[84:87], v4 offset:1024
    ds_read_b64 v[92:93], v5 offset:256
    ds_read_b128 v[96:99], v6 offset:0
    ds_read_b128 v[100:103], v6 offset:576
    s_waitcnt lgkmcnt(4)
    v_mfma_f32_32x32x16_bf16 v[32:47], v[80:83], v[16:19], 0
    v_mfma_f32_32x32x16_bf16 v[32:47], v[88:91], v[20:23], v[32:47]
    s_nop 15
    s_mov_b32 s21, 0
    s_cmp_eq_u32 s23, 1
    s_cbranch_scc1 K2_FLOOP_P0
K2_LOOP_P0:
    s_waitcnt lgkmcnt(2)
    v_mfma_f32_32x32x16_bf16 v[48:63], v[84:87], v[16:19], 0
    v_max3_f32 v10, v32, v33, v34
    v_max3_f32 v10, v10, v35, v36
    v_max3_f32 v10, v10, v37, v38
    v_max3_f32 v10, v10, v39, v40
    v_mfma_f32_32x32x16_bf16 v[48:63], v[92:95], v[20:23], v[48:63]
    v_max3_f32 v10, v10, v41, v42
    v_max3_f32 v10, v10, v43, v44
    v_max3_f32 v10, v10, v45, v46
    v_max_f32 v10, v10, v47
    v_cmp_lt_f32 vcc, s20, v10
    s_cbranch_vccnz K2_SLOW_P0_0
K2_BACK_P0_0:
    v_exp_f32 v32, v32
    v_exp_f32 v33, v33
    v_exp_f32 v34, v34
    v_exp_f32 v35, v35
    v_exp_f32 v36, v36
    v_exp_f32 v37, v37
    v_exp_f32 v38, v38
    v_exp_f32 v39, v39
    ds_read_b128 v[80:83], v4 offset:2048
    ds_read_b64 v[88:89], v5 offset:512
    ds_read_b128 v[104:107], v6 offset:1152
    ds_read_b128 v[108:111], v6 offset:1728
    v_cvt_pk_bf16_f32 v24, v32, v33
    v_cvt_pk_bf16_f32 v25, v34, v35
    v_cvt_pk_bf16_f32 v26, v36, v37
    v_cvt_pk_bf16_f32 v27, v38, v39
    v_exp_f32 v40, v40
    v_exp_f32 v41, v41
    v_exp_f32 v42, v42
    v_exp_f32 v43, v43
    s_waitcnt lgkmcnt(4)
    v_mfma_f32_32x32x16_bf16 v[64:79], v[96:99], v[24:27], v[64:79]
    v_exp_f32 v44, v44
    v_exp_f32 v45, v45
    v_exp_f32 v46, v46
    v_exp_f32 v47, v47
    s_nop 0
    v_cvt_pk_bf16_f32 v28, v40, v41
    v_cvt_pk_bf16_f32 v29, v42, v43
    v_cvt_pk_bf16_f32 v30, v44, v45
    v_cvt_pk_bf16_f32 v31, v46, v47
    s_nop 1
    v_mfma_f32_32x32x16_bf16 v[64:79], v[100:103], v[28:31], v[64:79]
    s_waitcnt lgkmcnt(2)
    v_mfma_f32_32x32x16_bf16 v[32:47], v[80:83], v[16:19], 0
    v_max3_f32 v10, v48, v49, v50
    v_max3_f32 v10, v10, v51, v52
    v_max3_f32 v10, v10, v53, v54
    v_max3_f32 v10, v10, v55, v56
    v_mfma_f32_32x32x16_bf16 v[32:47], v[88:91], v[20:23], v[32:47]
    v_max3_f32 v10, v10, v57, v58
    v_max3_f32 v10, v10, v59, v60
    v_max3_f32 v10, v10, v61, v62
    v_max_f32 v10, v10, v63
    v_cmp_lt_f32 vcc, s20, v10
    s_cbranch_vccnz K2_SLOW_P0_1
K2_BACK_P0_1:
    v_exp_f32 v48, v48
    v_exp_f32 v49, v49
    v_exp_f32 v50, v50
    v_exp_f32 v51, v51
    v_exp_f32 v52, v52
    v_exp_f32 v53, v53
    v_exp_f32 v54, v54
    v_exp_f32 v55, v55
    ds_read_b128 v[84:87], v4 offset:3072
    ds_read_b64 v[92:93], v5 offset:768
    ds_read_b128 v[96:99], v6 offset:2304
    ds_read_b128 v[100:103], v6 offset:2880
    v_cvt_pk_bf16_f32 v24, v48, v49
    v_cvt_pk_bf16_f32 v25, v50, v51
    v_cvt_pk_bf16_f32 v26, v52, v53
    v_cvt_pk_bf16_f32 v27, v54, v55
    v_exp_f32 v56, v56
    v_exp_f32 v57, v57
    v_exp_f32 v58, v58
    v_exp_f32 v59, v59
    s_waitcnt lgkmcnt(4)
    v_mfma_f32_32x32x16_bf16 v[64:79], v[104:107], v[24:27], v[64:79]
    v_exp_f32 v60, v60
    v_exp_f32 v61, v61
    v_exp_f32 v62, v62
    v_exp_f32 v63, v63
    s_nop 0
    v_cvt_pk_bf16_f32 v28, v56, v57
    v_cvt_pk_bf16_f32 v29, v58, v59
    v_cvt_pk_bf16_f32 v30, v60, v61
    v_cvt_pk_bf16_f32 v31, v62, v63
    s_nop 1
    v_mfma_f32_32x32x16_bf16 v[64:79], v[108:111], v[28:31], v[64:79]
    v_sub_f32 v11, v152, v9
    v_cmp_lt_f32 vcc, 0x42700000, v11
    v_cmp_u_f32 s[26:27], v11, v11
    s_or_b64 vcc, vcc, s[26:27]
    s_cmp_eq_u64 vcc, 0
    s_cselect_b32 s23, 1, 0
    v_add_u32 v4, 2048, v4
    v_add_u32 v5, v154, v5
    v_add_u32 v6, v155, v6
    s_add_u32 s21, s21, 1
    s_cmp_lt_u32 s21, 16
    s_cbranch_scc0 K2_LX_P0
    s_cmp_eq_u32 s23, 1
    s_cbranch_scc0 K2_LOOP_P0
K2_FLOOP_P0:
    s_waitcnt lgkmcnt(2)
    v_mfma_f32_32x32x16_bf16 v[48:63], v[84:87], v[16:19], 0
    v_exp_f32 v32, v32
    v_exp_f32 v33, v33
    v_exp_f32 v34, v34
    v_exp_f32 v35, v35
    v_mfma_f32_32x32x16_bf16 v[48:63], v[92:95], v[20:23], v[48:63]
    v_exp_f32 v36, v36
    v_exp_f32 v37, v37
    v_exp_f32 v38, v38
    v_exp_f32 v39, v39
    ds_read_b128 v[80:83], v4 offset:2048
    ds_read_b64 v[88:89], v5 offset:512
    ds_read_b128 v[104:107], v6 offset:1152
    ds_read_b128 v[108:111], v6 offset:1728
    v_cvt_pk_bf16_f32 v24, v32, v33
    v_cvt_pk_bf16_f32 v25, v34, v35
    v_cvt_pk_bf16_f32 v26, v36, v37
    v_cvt_pk_bf16_f32 v27, v38, v39
    v_exp_f32 v40, v40
    v_exp_f32 v41, v41
    v_exp_f32 v42, v42
    v_exp_f32 v43, v43
    s_waitcnt lgkmcnt(4)
    v_mfma_f32_32x32x16_bf16 v[64:79], v[96:99], v[24:27], v[64:79]
    v_exp_f32 v44, v44
    v_exp_f32 v45, v45
    v_exp_f32 v46, v46
    v_exp_f32 v47, v47
    s_nop 0
    v_cvt_pk_bf16_f32 v28, v40, v41
    v_cvt_pk_bf16_f32 v29, v42, v43
    v_cvt_pk_bf16_f32 v30, v44, v45
    v_cvt_pk_bf16_f32 v31, v46, v47
    s_nop 1
    v_mfma_f32_32x32x16_bf16 v[64:79], v[100:103], v[28:31], v[64:79]
    s_waitcnt lgkmcnt(2)
    v_mfma_f32_32x32x16_bf16 v[32:47], v[80:83], v[16:19], 0
    v_exp_f32 v48, v48
    v_exp_f32 v49, v49
    v_exp_f32 v50, v50
    v_exp_f32 v51, v51
    v_mfma_f32_32x32x16_bf16 v[32:47], v[88:91], v[20:23], v[32:47]
    v_exp_f32 v52, v52
    v_exp_f32 v53, v53
    v_exp_f32 v54, v54
    v_exp_f32 v55, v55
    ds_read_b128 v[84:87], v4 offset:3072
    ds_read_b64 v[92:93], v5 offset:768
    ds_read_b128 v[96:99], v6 offset:2304
    ds_read_b128 v[100:103], v6 offset:2880
    v_cvt_pk_bf16_f32 v24, v48, v49
    v_cvt_pk_bf16_f32 v25, v50, v51
    v_cvt_pk_bf16_f32 v26, v52, v53
    v_cvt_pk_bf16_f32 v27, v54, v55
    v_exp_f32 v56, v56
    v_exp_f32 v57, v57
    v_exp_f32 v58, v58
    v_exp_f32 v59, v59
    s_waitcnt lgkmcnt(4)
    v_mfma_f32_32x32x16_bf16 v[64:79], v[104:107], v[24:27], v[64:79]
    v_exp_f32 v60, v60
    v_exp_f32 v61, v61
    v_exp_f32 v62, v62
    v_exp_f32 v63, v63
    s_nop 0
    v_cvt_pk_bf16_f32 v28, v56, v57
    v_cvt_pk_bf16_f32 v29, v58, v59
    v_cvt_pk_bf16_f32 v30, v60, v61
    v_cvt_pk_bf16_f32 v31, v62, v63
    s_nop 1
    v_mfma_f32_32x32x16_bf16 v[64:79], v[108:111], v[28:31], v[64:79]
    v_add_u32 v4, 2048, v4
    v_add_u32 v5, v154, v5
    v_add_u32 v6, v155, v6
    s_add_u32 s21, s21, 1
    s_cmp_lt_u32 s21, 16
    s_cbranch_scc1 K2_FLOOP_P0
K2_LX_P0:
    s_waitcnt lgkmcnt(0)
    v_mov_b32 v11, 1
    ds_add_u32 v15, v11
K2_SPIN1:
    ds_read_b32 v11, v15
    s_waitcnt lgkmcnt(0)
    v_readfirstlane_b32 s22, v11
    s_cmp_ge_u32 s22, 512
    s_cbranch_scc1 K2_SPINX1
    s_sleep 1
    s_branch K2_SPIN1
K2_SPINX1:
    s_waitcnt vmcnt(0)
    ds_write_b128 v7, v[112:115] offset:0
    ds_write_b128 v7, v[116:119] offset:8192
    ds_write_b128 v7, v[120:123] offset:16384
    ds_write_b128 v7, v[124:127] offset:24576
    ds_write_b128 v7, v[128:131] offset:32768
    ds_write_b128 v7, v[132:135] offset:40960
    ds_write_b128 v7, v[136:139] offset:49152
    ds_write_b128 v7, v[140:143] offset:57344
    ds_write_b128 v14, v[144:147] offset:0
    s_cmp_lt_u32 s3, 4
    s_cbranch_scc0 K2_SW1
    ds_write_b128 v14, v[148:151] offset:8192
K2_SW1:
    v_subrev_u32 v4, 32768, v4
    v_mov_b32 v5, v156
    v_mov_b32 v6, v157
    s_waitcnt lgkmcnt(0)
    v_mov_b32 v11, 1
    ds_add_u32 v15, v11
K2_SPIN2:
    ds_read_b32 v11, v15
    s_waitcnt lgkmcnt(0)
    v_readfirstlane_b32 s22, v11
    s_cmp_ge_u32 s22, 1024
    s_cbranch_scc1 K2_SPINX2
    s_sleep 1
    s_branch K2_SPIN2
K2_SPINX2:
    ds_read_b128 v[80:83], v4 offset:0
    ds_read_b64 v[88:89], v5 offset:0
    ds_read_b128 v[84:87], v4 offset:1024
    ds_read_b64 v[92:93], v5 offset:256
    ds_read_b128 v[96:99], v6 offset:0
    ds_read_b128 v[100:103], v6 offset:576
    s_waitcnt lgkmcnt(4)
    v_mfma_f32_32x32x16_bf16 v[32:47], v[80:83], v[16:19], 0
    v_mfma_f32_32x32x16_bf16 v[32:47], v[88:91], v[20:23], v[32:47]
    s_nop 15
    s_mov_b32 s21, 0
    s_cmp_eq_u32 s23, 1
    s_cbranch_scc1 K2_FLOOP_P1
K2_LOOP_P1:
    s_waitcnt lgkmcnt(2)
    v_mfma_f32_32x32x16_bf16 v[48:63], v[84:87], v[16:19], 0
    v_max3_f32 v10, v32, v33, v34
    v_max3_f32 v10, v10, v35, v36
    v_max3_f32 v10, v10, v37, v38
    v_max3_f32 v10, v10, v39, v40
    v_mfma_f32_32x32x16_bf16 v[48:63], v[92:95], v[20:23], v[48:63]
    v_max3_f32 v10, v10, v41, v42
    v_max3_f32 v10, v10, v43, v44
    v_max3_f32 v10, v10, v45, v46
    v_max_f32 v10, v10, v47
    v_cmp_lt_f32 vcc, s20, v10
    s_cbranch_vccnz K2_SLOW_P1_0
K2_BACK_P1_0:
    v_exp_f32 v32, v32
    v_exp_f32 v33, v33
    v_exp_f32 v34, v34
    v_exp_f32 v35, v35
    v_exp_f32 v36, v36
    v_exp_f32 v37, v37
    v_exp_f32 v38, v38
    v_exp_f32 v39, v39
    ds_read_b128 v[80:83], v4 offset:2048
    ds_read_b64 v[88:89], v5 offset:512
    ds_read_b128 v[104:107], v6 offset:1152
    ds_read_b128 v[108:111], v6 offset:1728
    v_cvt_pk_bf16_f32 v24, v32, v33
    v_cvt_pk_bf16_f32 v25, v34, v35
    v_cvt_pk_bf16_f32 v26, v36, v37
    v_cvt_pk_bf16_f32 v27, v38, v39
    v_exp_f32 v40, v40
    v_exp_f32 v41, v41
    v_exp_f32 v42, v42
    v_exp_f32 v43, v43
    s_waitcnt lgkmcnt(4)
    v_mfma_f32_32x32x16_bf16 v[64:79], v[96:99], v[24:27], v[64:79]
    v_exp_f32 v44, v44
    v_exp_f32 v45, v45
    v_exp_f32 v46, v46
    v_exp_f32 v47, v47
    s_nop 0
    v_cvt_pk_bf16_f32 v28, v40, v41
    v_cvt_pk_bf16_f32 v29, v42, v43
    v_cvt_pk_bf16_f32 v30, v44, v45
    v_cvt_pk_bf16_f32 v31, v46, v47
    s_nop 1
    v_mfma_f32_32x32x16_bf16 v[64:79], v[100:103], v[28:31], v[64:79]
    s_waitcnt lgkmcnt(2)
    v_mfma_f32_32x32x16_bf16 v[32:47], v[80:83], v[16:19], 0
    v_max3_f32 v10, v48, v49, v50
    v_max3_f32 v10, v10, v51, v52
    v_max3_f32 v10, v10, v53, v54
    v_max3_f32 v10, v10, v55, v56
    v_mfma_f32_32x32x16_bf16 v[32:47], v[88:91], v[20:23], v[32:47]
    v_max3_f32 v10, v10, v57, v58
    v_max3_f32 v10, v10, v59, v60
    v_max3_f32 v10, v10, v61, v62
    v_max_f32 v10, v10, v63
    v_cmp_lt_f32 vcc, s20, v10
    s_cbranch_vccnz K2_SLOW_P1_1
K2_BACK_P1_1:
    v_exp_f32 v48, v48
    v_exp_f32 v49, v49
    v_exp_f32 v50, v50
    v_exp_f32 v51, v51
    v_exp_f32 v52, v52
    v_exp_f32 v53, v53
    v_exp_f32 v54, v54
    v_exp_f32 v55, v55
    ds_read_b128 v[84:87], v4 offset:3072
    ds_read_b64 v[92:93], v5 offset:768
    ds_read_b128 v[96:99], v6 offset:2304
    ds_read_b128 v[100:103], v6 offset:2880
    v_cvt_pk_bf16_f32 v24, v48, v49
    v_cvt_pk_bf16_f32 v25, v50, v51
    v_cvt_pk_bf16_f32 v26, v52, v53
    v_cvt_pk_bf16_f32 v27, v54, v55
    v_exp_f32 v56, v56
    v_exp_f32 v57, v57
    v_exp_f32 v58, v58
    v_exp_f32 v59, v59
    s_waitcnt lgkmcnt(4)
    v_mfma_f32_32x32x16_bf16 v[64:79], v[104:107], v[24:27], v[64:79]
    v_exp_f32 v60, v60
    v_exp_f32 v61, v61
    v_exp_f32 v62, v62
    v_exp_f32 v63, v63
    s_nop 0
    v_cvt_pk_bf16_f32 v28, v56, v57
    v_cvt_pk_bf16_f32 v29, v58, v59
    v_cvt_pk_bf16_f32 v30, v60, v61
    v_cvt_pk_bf16_f32 v31, v62, v63
    s_nop 1
    v_mfma_f32_32x32x16_bf16 v[64:79], v[108:111], v[28:31], v[64:79]
    v_sub_f32 v11, v152, v9
    v_cmp_lt_f32 vcc, 0x42700000, v11
    v_cmp_u_f32 s[26:27], v11, v11
    s_or_b64 vcc, vcc, s[26:27]
    s_cmp_eq_u64 vcc, 0
    s_cselect_b32 s23, 1, 0
    v_add_u32 v4, 2048, v4
    v_add_u32 v5, v154, v5
    v_add_u32 v6, v155, v6
    s_add_u32 s21, s21, 1
    s_cmp_lt_u32 s21, 16
    s_cbranch_scc0 K2_LX_P1
    s_cmp_eq_u32 s23, 1
    s_cbranch_scc0 K2_LOOP_P1
K2_FLOOP_P1:
    s_waitcnt lgkmcnt(2)
    v_mfma_f32_32x32x16_bf16 v[48:63], v[84:87], v[16:19], 0
    v_exp_f32 v32, v32
    v_exp_f32 v33, v33
    v_exp_f32 v34, v34
    v_exp_f32 v35, v35
    v_mfma_f32_32x32x16_bf16 v[48:63], v[92:95], v[20:23], v[48:63]
    v_exp_f32 v36, v36
    v_exp_f32 v37, v37
    v_exp_f32 v38, v38
    v_exp_f32 v39, v39
    ds_read_b128 v[80:83], v4 offset:2048
    ds_read_b64 v[88:89], v5 offset:512
    ds_read_b128 v[104:107], v6 offset:1152
    ds_read_b128 v[108:111], v6 offset:1728
    v_cvt_pk_bf16_f32 v24, v32, v33
    v_cvt_pk_bf16_f32 v25, v34, v35
    v_cvt_pk_bf16_f32 v26, v36, v37
    v_cvt_pk_bf16_f32 v27, v38, v39
    v_exp_f32 v40, v40
    v_exp_f32 v41, v41
    v_exp_f32 v42, v42
    v_exp_f32 v43, v43
    s_waitcnt lgkmcnt(4)
    v_mfma_f32_32x32x16_bf16 v[64:79], v[96:99], v[24:27], v[64:79]
    v_exp_f32 v44, v44
    v_exp_f32 v45, v45
    v_exp_f32 v46, v46
    v_exp_f32 v47, v47
    s_nop 0
    v_cvt_pk_bf16_f32 v28, v40, v41
    v_cvt_pk_bf16_f32 v29, v42, v43
    v_cvt_pk_bf16_f32 v30, v44, v45
    v_cvt_pk_bf16_f32 v31, v46, v47
    s_nop 1
    v_mfma_f32_32x32x16_bf16 v[64:79], v[100:103], v[28:31], v[64:79]
    s_waitcnt lgkmcnt(2)
    v_mfma_f32_32x32x16_bf16 v[32:47], v[80:83], v[16:19], 0
    v_exp_f32 v48, v48
    v_exp_f32 v49, v49
    v_exp_f32 v50, v50
    v_exp_f32 v51, v51
    v_mfma_f32_32x32x16_bf16 v[32:47], v[88:91], v[20:23], v[32:47]
    v_exp_f32 v52, v52
    v_exp_f32 v53, v53
    v_exp_f32 v54, v54
    v_exp_f32 v55, v55
    ds_read_b128 v[84:87], v4 offset:3072
    ds_read_b64 v[92:93], v5 offset:768
    ds_read_b128 v[96:99], v6 offset:2304
    ds_read_b128 v[100:103], v6 offset:2880
    v_cvt_pk_bf16_f32 v24, v48, v49
    v_cvt_pk_bf16_f32 v25, v50, v51
    v_cvt_pk_bf16_f32 v26, v52, v53
    v_cvt_pk_bf16_f32 v27, v54, v55
    v_exp_f32 v56, v56
    v_exp_f32 v57, v57
    v_exp_f32 v58, v58
    v_exp_f32 v59, v59
    s_waitcnt lgkmcnt(4)
    v_mfma_f32_32x32x16_bf16 v[64:79], v[104:107], v[24:27], v[64:79]
    v_exp_f32 v60, v60
    v_exp_f32 v61, v61
    v_exp_f32 v62, v62
    v_exp_f32 v63, v63
    s_nop 0
    v_cvt_pk_bf16_f32 v28, v56, v57
    v_cvt_pk_bf16_f32 v29, v58, v59
    v_cvt_pk_bf16_f32 v30, v60, v61
    v_cvt_pk_bf16_f32 v31, v62, v63
    s_nop 1
    v_mfma_f32_32x32x16_bf16 v[64:79], v[108:111], v[28:31], v[64:79]
    v_add_u32 v4, 2048, v4
    v_add_u32 v5, v154, v5
    v_add_u32 v6, v155, v6
    s_add_u32 s21, s21, 1
    s_cmp_lt_u32 s21, 16
    s_cbranch_scc1 K2_FLOOP_P1
K2_LX_P1:
    s_branch K2_FIN
K2_SLOW_P0_0:
    v_mov_b32 v11, v10
    v_mov_b32 v12, v10
    s_nop 1
    v_permlane32_swap_b32 v11, v12
    s_nop 1
    v_max_f32 v11, v11, v12
    s_cmp_lt_i32 s20, 0
    s_cbranch_scc1 K2_SL1_P0_0
    v_max_f32 v11, 0, v11
K2_SL1_P0_0:
    s_mov_b32 s20, 1090519040
    v_add_f32 v12, v9, v11
    v_bfe_u32 v11, v12, 16, 1
    v_add3_u32 v12, v12, v11, s90
    v_and_b32 v12, 0xffff0000, v12
    v_sub_f32 v11, v12, v9
    v_mov_b32 v9, v12
    s_nop 15
    s_nop 7
    v_sub_f32 v32, v32, v11
    v_sub_f32 v48, v48, v11
    v_sub_f32 v33, v33, v11
    v_sub_f32 v49, v49, v11
    v_sub_f32 v34, v34, v11
    v_sub_f32 v50, v50, v11
    v_sub_f32 v35, v35, v11
    v_sub_f32 v51, v51, v11
    v_sub_f32 v36, v36, v11
    v_sub_f32 v52, v52, v11
    v_sub_f32 v37, v37, v11
    v_sub_f32 v53, v53, v11
    v_sub_f32 v38, v38, v11
    v_sub_f32 v54, v54, v11
    v_sub_f32 v39, v39, v11
    v_sub_f32 v55, v55, v11
    v_sub_f32 v40, v40, v11
    v_sub_f32 v56, v56, v11
    v_sub_f32 v41, v41, v11
    v_sub_f32 v57, v57, v11
    v_sub_f32 v42, v42, v11
    v_sub_f32 v58, v58, v11
    v_sub_f32 v43, v43, v11
    v_sub_f32 v59, v59, v11
    v_sub_f32 v44, v44, v11
    v_sub_f32 v60, v60, v11
    v_sub_f32 v45, v45, v11
    v_sub_f32 v61, v61, v11
    v_sub_f32 v46, v46, v11
    v_sub_f32 v62, v62, v11
    v_sub_f32 v47, v47, v11
    v_sub_f32 v63, v63, v11
    v_sub_f32 v11, 0, v11
    v_exp_f32 v11, v11
    s_nop 0
    v_mul_f32 v64, v64, v11
    v_mul_f32 v65, v65, v11
    v_mul_f32 v66, v66, v11
    v_mul_f32 v67, v67, v11
    v_mul_f32 v68, v68, v11
    v_mul_f32 v69, v69, v11
    v_mul_f32 v70, v70, v11
    v_mul_f32 v71, v71, v11
    v_mul_f32 v72, v72, v11
    v_mul_f32 v73, v73, v11
    v_mul_f32 v74, v74, v11
    v_mul_f32 v75, v75, v11
    v_mul_f32 v76, v76, v11
    v_mul_f32 v77, v77, v11
    v_mul_f32 v78, v78, v11
    v_mul_f32 v79, v79, v11
    v_xor_b32 v12, 0x80000000, v12
    v_lshrrev_b32 v12, 16, v12
    s_mov_b64 exec, s[16:17]
    v_mov_b32 v21, v12
    s_mov_b64 exec, -1
    s_nop 1
    s_branch K2_BACK_P0_0
K2_SLOW_P0_1:
    v_mov_b32 v11, v10
    v_mov_b32 v12, v10
    s_nop 1
    v_permlane32_swap_b32 v11, v12
    s_nop 1
    v_max_f32 v11, v11, v12
    s_cmp_lt_i32 s20, 0
    s_cbranch_scc1 K2_SL1_P0_1
    v_max_f32 v11, 0, v11
K2_SL1_P0_1:
    s_mov_b32 s20, 1090519040
    v_add_f32 v12, v9, v11
    v_bfe_u32 v11, v12, 16, 1
    v_add3_u32 v12, v12, v11, s90
    v_and_b32 v12, 0xffff0000, v12
    v_sub_f32 v11, v12, v9
    v_mov_b32 v9, v12
    s_nop 15
    s_nop 7
    v_sub_f32 v48, v48, v11
    v_sub_f32 v32, v32, v11
    v_sub_f32 v49, v49, v11
    v_sub_f32 v33, v33, v11
    v_sub_f32 v50, v50, v11
    v_sub_f32 v34, v34, v11
    v_sub_f32 v51, v51, v11
    v_sub_f32 v35, v35, v11
    v_sub_f32 v52, v52, v11
    v_sub_f32 v36, v36, v11
    v_sub_f32 v53, v53, v11
    v_sub_f32 v37, v37, v11
    v_sub_f32 v54, v54, v11
    v_sub_f32 v38, v38, v11
    v_sub_f32 v55, v55, v11
    v_sub_f32 v39, v39, v11
    v_sub_f32 v56, v56, v11
    v_sub_f32 v40, v40, v11
    v_sub_f32 v57, v57, v11
    v_sub_f32 v41, v41, v11
    v_sub_f32 v58, v58, v11
    v_sub_f32 v42, v42, v11
    v_sub_f32 v59, v59, v11
    v_sub_f32 v43, v43, v11
    v_sub_f32 v60, v60, v11
    v_sub_f32 v44, v44, v11
    v_sub_f32 v61, v61, v11
    v_sub_f32 v45, v45, v11
    v_sub_f32 v62, v62, v11
    v_sub_f32 v46, v46, v11
    v_sub_f32 v63, v63, v11
    v_sub_f32 v47, v47, v11
    v_sub_f32 v11, 0, v11
    v_exp_f32 v11, v11
    s_nop 0
    v_mul_f32 v64, v64, v11
    v_mul_f32 v65, v65, v11
    v_mul_f32 v66, v66, v11
    v_mul_f32 v67, v67, v11
    v_mul_f32 v68, v68, v11
    v_mul_f32 v69, v69, v11
    v_mul_f32 v70, v70, v11
    v_mul_f32 v71, v71, v11
    v_mul_f32 v72, v72, v11
    v_mul_f32 v73, v73, v11
    v_mul_f32 v74, v74, v11
    v_mul_f32 v75, v75, v11
    v_mul_f32 v76, v76, v11
    v_mul_f32 v77, v77, v11
    v_mul_f32 v78, v78, v11
    v_mul_f32 v79, v79, v11
    v_xor_b32 v12, 0x80000000, v12
    v_lshrrev_b32 v12, 16, v12
    s_mov_b64 exec, s[16:17]
    v_mov_b32 v21, v12
    s_mov_b64 exec, -1
    s_nop 1
    s_branch K2_BACK_P0_1
K2_SLOW_P1_0:
    v_mov_b32 v11, v10
    v_mov_b32 v12, v10
    s_nop 1
    v_permlane32_swap_b32 v11, v12
    s_nop 1
    v_max_f32 v11, v11, v12
    s_cmp_lt_i32 s20, 0
    s_cbranch_scc1 K2_SL1_P1_0
    v_max_f32 v11, 0, v11
K2_SL1_P1_0:
    s_mov_b32 s20, 1090519040
    v_add_f32 v12, v9, v11
    v_bfe_u32 v11, v12, 16, 1
    v_add3_u32 v12, v12, v11, s90
    v_and_b32 v12, 0xffff0000, v12
    v_sub_f32 v11, v12, v9
    v_mov_b32 v9, v12
    s_nop 15
    s_nop 7
    v_sub_f32 v32, v32, v11
    v_sub_f32 v48, v48, v11
    v_sub_f32 v33, v33, v11
    v_sub_f32 v49, v49, v11
    v_sub_f32 v34, v34, v11
    v_sub_f32 v50, v50, v11
    v_sub_f32 v35, v35, v11
    v_sub_f32 v51, v51, v11
    v_sub_f32 v36, v36, v11
    v_sub_f32 v52, v52, v11
    v_sub_f32 v37, v37, v11
    v_sub_f32 v53, v53, v11
    v_sub_f32 v38, v38, v11
    v_sub_f32 v54, v54, v11
    v_sub_f32 v39, v39, v11
    v_sub_f32 v55, v55, v11
    v_sub_f32 v40, v40, v11
    v_sub_f32 v56, v56, v11
    v_sub_f32 v41, v41, v11
    v_sub_f32 v57, v57, v11
    v_sub_f32 v42, v42, v11
    v_sub_f32 v58, v58, v11
    v_sub_f32 v43, v43, v11
    v_sub_f32 v59, v59, v11
    v_sub_f32 v44, v44, v11
    v_sub_f32 v60, v60, v11
    v_sub_f32 v45, v45, v11
    v_sub_f32 v61, v61, v11
    v_sub_f32 v46, v46, v11
    v_sub_f32 v62, v62, v11
    v_sub_f32 v47, v47, v11
    v_sub_f32 v63, v63, v11
    v_sub_f32 v11, 0, v11
    v_exp_f32 v11, v11
    s_nop 0
    v_mul_f32 v64, v64, v11
    v_mul_f32 v65, v65, v11
    v_mul_f32 v66, v66, v11
    v_mul_f32 v67, v67, v11
    v_mul_f32 v68, v68, v11
    v_mul_f32 v69, v69, v11
    v_mul_f32 v70, v70, v11
    v_mul_f32 v71, v71, v11
    v_mul_f32 v72, v72, v11
    v_mul_f32 v73, v73, v11
    v_mul_f32 v74, v74, v11
    v_mul_f32 v75, v75, v11
    v_mul_f32 v76, v76, v11
    v_mul_f32 v77, v77, v11
    v_mul_f32 v78, v78, v11
    v_mul_f32 v79, v79, v11
    v_xor_b32 v12, 0x80000000, v12
    v_lshrrev_b32 v12, 16, v12
    s_mov_b64 exec, s[16:17]
    v_mov_b32 v21, v12
    s_mov_b64 exec, -1
    s_nop 1
    s_branch K2_BACK_P1_0
K2_SLOW_P1_1:
    v_mov_b32 v11, v10
    v_mov_b32 v12, v10
    s_nop 1
    v_permlane32_swap_b32 v11, v12
    s_nop 1
    v_max_f32 v11, v11, v12
    s_cmp_lt_i32 s20, 0
    s_cbranch_scc1 K2_SL1_P1_1
    v_max_f32 v11, 0, v11
K2_SL1_P1_1:
    s_mov_b32 s20, 1090519040
    v_add_f32 v12, v9, v11
    v_bfe_u32 v11, v12, 16, 1
    v_add3_u32 v12, v12, v11, s90
    v_and_b32 v12, 0xffff0000, v12
    v_sub_f32 v11, v12, v9
    v_mov_b32 v9, v12
    s_nop 15
    s_nop 7
    v_sub_f32 v48, v48, v11
    v_sub_f32 v32, v32, v11
    v_sub_f32 v49, v49, v11
    v_sub_f32 v33, v33, v11
    v_sub_f32 v50, v50, v11
    v_sub_f32 v34, v34, v11
    v_sub_f32 v51, v51, v11
    v_sub_f32 v35, v35, v11
    v_sub_f32 v52, v52, v11
    v_sub_f32 v36, v36, v11
    v_sub_f32 v53, v53, v11
    v_sub_f32 v37, v37, v11
    v_sub_f32 v54, v54, v11
    v_sub_f32 v38, v38, v11
    v_sub_f32 v55, v55, v11
    v_sub_f32 v39, v39, v11
    v_sub_f32 v56, v56, v11
    v_sub_f32 v40, v40, v11
    v_sub_f32 v57, v57, v11
    v_sub_f32 v41, v41, v11
    v_sub_f32 v58, v58, v11
    v_sub_f32 v42, v42, v11
    v_sub_f32 v59, v59, v11
    v_sub_f32 v43, v43, v11
    v_sub_f32 v60, v60, v11
    v_sub_f32 v44, v44, v11
    v_sub_f32 v61, v61, v11
    v_sub_f32 v45, v45, v11
    v_sub_f32 v62, v62, v11
    v_sub_f32 v46, v46, v11
    v_sub_f32 v63, v63, v11
    v_sub_f32 v47, v47, v11
    v_sub_f32 v11, 0, v11
    v_exp_f32 v11, v11
    s_nop 0
    v_mul_f32 v64, v64, v11
    v_mul_f32 v65, v65, v11
    v_mul_f32 v66, v66, v11
    v_mul_f32 v67, v67, v11
    v_mul_f32 v68, v68, v11
    v_mul_f32 v69, v69, v11
    v_mul_f32 v70, v70, v11
    v_mul_f32 v71, v71, v11
    v_mul_f32 v72, v72, v11
    v_mul_f32 v73, v73, v11
    v_mul_f32 v74, v74, v11
    v_mul_f32 v75, v75, v11
    v_mul_f32 v76, v76, v11
    v_mul_f32 v77, v77, v11
    v_mul_f32 v78, v78, v11
    v_mul_f32 v79, v79, v11
    v_xor_b32 v12, 0x80000000, v12
    v_lshrrev_b32 v12, 16, v12
    s_mov_b64 exec, s[16:17]
    v_mov_b32 v21, v12
    s_mov_b64 exec, -1
    s_nop 1
    s_branch K2_BACK_P1_1
K2_FIN:
    s_nop 15
    s_nop 3
    v_mov_b32 v11, v74
    v_mov_b32 v12, v74
    s_nop 1
    v_permlane32_swap_b32 v11, v12
    s_nop 1
    v_rcp_f32 v11, v11
    s_nop 0
    v_mul_f32 v64, v64, v11
    v_mul_f32 v65, v65, v11
    v_mul_f32 v66, v66, v11
    v_mul_f32 v67, v67, v11
    v_mul_f32 v68, v68, v11
    v_mul_f32 v69, v69, v11
    v_mul_f32 v70, v70, v11
    v_mul_f32 v71, v71, v11
    v_mul_f32 v72, v72, v11
    v_mul_f32 v73, v73, v11
    v_cvt_pk_bf16_f32 v24, v64, v65
    v_cvt_pk_bf16_f32 v25, v66, v67
    v_cvt_pk_bf16_f32 v26, v68, v69
    v_cvt_pk_bf16_f32 v27, v70, v71
    v_cvt_pk_bf16_f32 v28, v72, v73
    v_lshl_add_u32 v12, v2, 3, v158
    global_store_dwordx2 v12, v[24:25], s[12:13]
    global_store_dwordx2 v12, v[26:27], s[12:13] offset:16
    s_mov_b64 exec, s[16:17]
    global_store_dword v12, v28, s[12:13] offset:32
    s_endpgm
K2_CONV:
    s_sub_u32 s3, s3, 8
    s_lshl_b32 s14, s3, 8
    s_add_u32 s14, s14, s2
    s_cmp_ge_u32 s14, 576
    s_cbranch_scc1 K2_END2
    v_and_b32 v1, 63, v0
    v_lshrrev_b32 v2, 5, v1
    v_and_b32 v3, 31, v1
    s_waitcnt lgkmcnt(0)
    s_add_u32 s8, s6, 4890624
    s_addc_u32 s9, s7, 0
    s_add_u32 s10, s6, 12124160
    s_addc_u32 s11, s7, 0
    s_add_u32 s12, s6, 9764864
    s_addc_u32 s13, s7, 0
    s_mul_i32 s15, s3, 23168
    s_add_u32 s15, s15, 77824
    v_lshlrev_b32 v6, 4, v1
    s_mov_b32 s24, 0x3ff
    s_mov_b32 s25, 0
    s_mul_i32 s16, s14, 8448
    v_add_u32 v9, s15, v6
    s_add_u32 s17, s16, 0
    v_add_u32 v7, s17, v6
    global_load_dwordx4 v[16:19], v7, s[8:9] offset:0
    global_load_dwordx4 v[20:23], v7, s[8:9] offset:1024
    global_load_dwordx4 v[24:27], v7, s[8:9] offset:2048
    global_load_dwordx4 v[28:31], v7, s[8:9] offset:3072
    v_add_u32 v7, 4096, v7
    global_load_dwordx4 v[32:35], v7, s[8:9]
    s_add_u32 s17, s16, 4224
    v_add_u32 v7, s17, v6
    global_load_dwordx4 v[36:39], v7, s[8:9] offset:0
    global_load_dwordx4 v[40:43], v7, s[8:9] offset:1024
    global_load_dwordx4 v[44:47], v7, s[8:9] offset:2048
    global_load_dwordx4 v[48:51], v7, s[8:9] offset:3072
    v_add_u32 v7, 4096, v7
    global_load_dwordx4 v[52:55], v7, s[8:9]
    s_add_u32 s17, s16, 4
    v_add_u32 v7, s17, v6
    global_load_dwordx4 v[56:59], v7, s[8:9] offset:0
    global_load_dwordx4 v[60:63], v7, s[8:9] offset:1024
    global_load_dwordx4 v[64:67], v7, s[8:9] offset:2048
    global_load_dwordx4 v[68:71], v7, s[8:9] offset:3072
    v_add_u32 v7, 4096, v7
    global_load_dwordx4 v[72:75], v7, s[8:9]
    s_add_u32 s17, s16, 4228
    v_add_u32 v7, s17, v6
    global_load_dwordx4 v[76:79], v7, s[8:9] offset:0
    global_load_dwordx4 v[80:83], v7, s[8:9] offset:1024
    global_load_dwordx4 v[84:87], v7, s[8:9] offset:2048
    global_load_dwordx4 v[88:91], v7, s[8:9] offset:3072
    v_add_u32 v7, 4096, v7
    global_load_dwordx4 v[92:95], v7, s[8:9]
    s_lshl_b32 s17, s14, 12
    v_add_u32 v7, s17, v6
    global_load_dwordx4 v[96:99], v7, s[10:11] offset:0
    global_load_dwordx4 v[100:103], v7, s[10:11] offset:1024
    global_load_dwordx4 v[104:107], v7, s[10:11] offset:2048
    global_load_dwordx4 v[108:111], v7, s[10:11] offset:3072
    s_barrier
    v_mov_b32 v112, 0
    v_mov_b32 v113, 0
    v_mov_b32 v114, 0
    v_mov_b32 v115, 0
    ds_write_b128 v9, v[112:115] offset:17024
    ds_write_b128 v9, v[112:115] offset:18048
    s_waitcnt vmcnt(0)
    ds_write_b128 v9, v[16:19] offset:0
    ds_write_b128 v9, v[20:23] offset:1024
    ds_write_b128 v9, v[24:27] offset:2048
    ds_write_b128 v9, v[28:31] offset:3072
    ds_write_b128 v9, v[36:39] offset:4256
    ds_write_b128 v9, v[40:43] offset:5280
    ds_write_b128 v9, v[44:47] offset:6304
    ds_write_b128 v9, v[48:51] offset:7328
    ds_write_b128 v9, v[56:59] offset:8512
    ds_write_b128 v9, v[60:63] offset:9536
    ds_write_b128 v9, v[64:67] offset:10560
    ds_write_b128 v9, v[68:71] offset:11584
    ds_write_b128 v9, v[76:79] offset:12768
    ds_write_b128 v9, v[80:83] offset:13792
    ds_write_b128 v9, v[84:87] offset:14816
    ds_write_b128 v9, v[88:91] offset:15840
    s_mov_b64 exec, s[24:25]
    ds_write_b128 v9, v[32:35] offset:4096
    ds_write_b128 v9, v[52:55] offset:8352
    ds_write_b128 v9, v[72:75] offset:12608
    ds_write_b128 v9, v[92:95] offset:16864
    s_mov_b64 exec, -1
    ds_write_b128 v9, v[96:99] offset:19072
    ds_write_b128 v9, v[100:103] offset:20096
    ds_write_b128 v9, v[104:107] offset:21120
    ds_write_b128 v9, v[108:111] offset:22144
    v_lshlrev_b32 v10, 3, v2
    v_sub_u32 v10, v10, v3
    v_add_u32 v10, 2047, v10
    v_and_b32 v11, 3, v10
    v_sub_u32 v10, v10, v11
    v_lshlrev_b32 v10, 1, v10
    s_movk_i32 s17, 4256
    v_mul_lo_u32 v11, v11, s17
    v_add3_u32 v4, v10, v11, s15
    v_lshlrev_b32 v5, 6, v3
    v_lshl_add_u32 v5, v2, 4, v5
    v_add_u32 v5, s15, v5
    v_add_u32 v5, 19072, v5
    v_mov_b32 v64, 0
    v_mov_b32 v65, 0
    v_mov_b32 v66, 0
    v_mov_b32 v67, 0
    v_mov_b32 v68, 0
    v_mov_b32 v69, 0
    v_mov_b32 v70, 0
    v_mov_b32 v71, 0
    v_mov_b32 v72, 0
    v_mov_b32 v73, 0
    v_mov_b32 v74, 0
    v_mov_b32 v75, 0
    v_mov_b32 v76, 0
    v_mov_b32 v77, 0
    v_mov_b32 v78, 0
    v_mov_b32 v79, 0
    v_mov_b32 v80, 0
    v_mov_b32 v81, 0
    v_mov_b32 v82, 0
    v_mov_b32 v83, 0
    v_mov_b32 v84, 0
    v_mov_b32 v85, 0
    v_mov_b32 v86, 0
    v_mov_b32 v87, 0
    v_mov_b32 v88, 0
    v_mov_b32 v89, 0
    v_mov_b32 v90, 0
    v_mov_b32 v91, 0
    v_mov_b32 v92, 0
    v_mov_b32 v93, 0
    v_mov_b32 v94, 0
    v_mov_b32 v95, 0
    s_waitcnt lgkmcnt(0)
    ds_read2_b64 v[16:19], v4 offset0:0 offset1:1
    ds_read2_b64 v[20:23], v4 offset0:4 offset1:5
    ds_read_b128 v[32:35], v5
    ds_read_b128 v[36:39], v5 offset:32
    ds_read_b128 v[40:43], v5 offset:2048
    ds_read_b128 v[44:47], v5 offset:2080
    v_subrev_u32 v4, 64, v4
    v_subrev_u32 v5, 64, v5
    s_mov_b32 s17, 0
K2_CV1:
    ds_read2_b64 v[24:27], v4 offset0:0 offset1:1
    ds_read2_b64 v[28:31], v4 offset0:4 offset1:5
    ds_read_b128 v[48:51], v5
    ds_read_b128 v[52:55], v5 offset:32
    ds_read_b128 v[56:59], v5 offset:2048
    ds_read_b128 v[60:63], v5 offset:2080
    v_subrev_u32 v4, 64, v4
    v_subrev_u32 v5, 64, v5
    s_waitcnt lgkmcnt(6)
    v_mfma_f32_32x32x16_bf16 v[64:79], v[16:19], v[32:35], v[64:79]
    v_mfma_f32_32x32x16_bf16 v[64:79], v[20:23], v[36:39], v[64:79]
    v_mfma_f32_32x32x16_bf16 v[80:95], v[16:19], v[40:43], v[80:95]
    v_mfma_f32_32x32x16_bf16 v[80:95], v[20:23], v[44:47], v[80:95]
    s_add_u32 s17, s17, 1
    s_cmp_lt_u32 s17, 16
    s_cbranch_scc0 K2_CV1X
    ds_read2_b64 v[16:19], v4 offset0:0 offset1:1
    ds_read2_b64 v[20:23], v4 offset0:4 offset1:5
    ds_read_b128 v[32:35], v5
    ds_read_b128 v[36:39], v5 offset:32
    ds_read_b128 v[40:43], v5 offset:2048
    ds_read_b128 v[44:47], v5 offset:2080
    v_subrev_u32 v4, 64, v4
    v_subrev_u32 v5, 64, v5
    s_waitcnt lgkmcnt(6)
    v_mfma_f32_32x32x16_bf16 v[64:79], v[24:27], v[48:51], v[64:79]
    v_mfma_f32_32x32x16_bf16 v[64:79], v[28:31], v[52:55], v[64:79]
    v_mfma_f32_32x32x16_bf16 v[80:95], v[24:27], v[56:59], v[80:95]
    v_mfma_f32_32x32x16_bf16 v[80:95], v[28:31], v[60:63], v[80:95]
    s_branch K2_CV1
K2_CV1X:
    ds_read2_b64 v[16:19], v4 offset0:0 offset1:1
    ds_read2_b64 v[20:23], v4 offset0:4 offset1:5
    ds_read_b128 v[40:43], v5 offset:2048
    ds_read_b128 v[44:47], v5 offset:2080
    v_subrev_u32 v4, 64, v4
    v_subrev_u32 v5, 64, v5
    s_waitcnt lgkmcnt(4)
    v_mfma_f32_32x32x16_bf16 v[64:79], v[24:27], v[48:51], v[64:79]
    v_mfma_f32_32x32x16_bf16 v[64:79], v[28:31], v[52:55], v[64:79]
    v_mfma_f32_32x32x16_bf16 v[80:95], v[24:27], v[56:59], v[80:95]
    v_mfma_f32_32x32x16_bf16 v[80:95], v[28:31], v[60:63], v[80:95]
    s_mov_b32 s17, 0
K2_CV2:
    ds_read2_b64 v[24:27], v4 offset0:0 offset1:1
    ds_read2_b64 v[28:31], v4 offset0:4 offset1:5
    ds_read_b128 v[56:59], v5 offset:2048
    ds_read_b128 v[60:63], v5 offset:2080
    v_subrev_u32 v4, 64, v4
    v_subrev_u32 v5, 64, v5
    s_waitcnt lgkmcnt(4)
    v_mfma_f32_32x32x16_bf16 v[80:95], v[16:19], v[40:43], v[80:95]
    v_mfma_f32_32x32x16_bf16 v[80:95], v[20:23], v[44:47], v[80:95]
    s_add_u32 s17, s17, 1
    s_cmp_lt_u32 s17, 16
    s_cbranch_scc0 K2_CV2X
    ds_read2_b64 v[16:19], v4 offset0:0 offset1:1
    ds_read2_b64 v[20:23], v4 offset0:4 offset1:5
    ds_read_b128 v[40:43], v5 offset:2048
    ds_read_b128 v[44:47], v5 offset:2080
    v_subrev_u32 v4, 64, v4
    v_subrev_u32 v5, 64, v5
    s_waitcnt lgkmcnt(4)
    v_mfma_f32_32x32x16_bf16 v[80:95], v[24:27], v[56:59], v[80:95]
    v_mfma_f32_32x32x16_bf16 v[80:95], v[28:31], v[60:63], v[80:95]
    s_branch K2_CV2
K2_CV2X:
    s_waitcnt lgkmcnt(0)
    v_mfma_f32_32x32x16_bf16 v[80:95], v[24:27], v[56:59], v[80:95]
    v_mfma_f32_32x32x16_bf16 v[80:95], v[28:31], v[60:63], v[80:95]
    s_nop 15
    s_nop 3
    v_lshlrev_b32 v10, 6, v3
    v_lshl_add_u32 v10, v2, 3, v10
    s_lshl_b32 s16, s14, 12
    v_add_u32 v10, s16, v10
    v_cvt_pk_bf16_f32 v64, v64, v65
    v_cvt_pk_bf16_f32 v65, v66, v67
    global_store_dwordx2 v10, v[64:65], s[12:13] offset:0
    v_cvt_pk_bf16_f32 v68, v68, v69
    v_cvt_pk_bf16_f32 v69, v70, v71
    global_store_dwordx2 v10, v[68:69], s[12:13] offset:16
    v_cvt_pk_bf16_f32 v72, v72, v73
    v_cvt_pk_bf16_f32 v73, v74, v75
    global_store_dwordx2 v10, v[72:73], s[12:13] offset:32
    v_cvt_pk_bf16_f32 v76, v76, v77
    v_cvt_pk_bf16_f32 v77, v78, v79
    global_store_dwordx2 v10, v[76:77], s[12:13] offset:48
    v_cvt_pk_bf16_f32 v80, v80, v81
    v_cvt_pk_bf16_f32 v81, v82, v83
    global_store_dwordx2 v10, v[80:81], s[12:13] offset:2048
    v_cvt_pk_bf16_f32 v84, v84, v85
    v_cvt_pk_bf16_f32 v85, v86, v87
    global_store_dwordx2 v10, v[84:85], s[12:13] offset:2064
    v_cvt_pk_bf16_f32 v88, v88, v89
    v_cvt_pk_bf16_f32 v89, v90, v91
    global_store_dwordx2 v10, v[88:89], s[12:13] offset:2080
    v_cvt_pk_bf16_f32 v92, v92, v93
    v_cvt_pk_bf16_f32 v93, v94, v95
    global_store_dwordx2 v10, v[92:93], s[12:13] offset:2096
K2_END2:
    s_endpgm
K2_END:
    s_endpgm
.text
.globl outp_kernel
.p2align 8
.type outp_kernel,@function
outp_kernel:
    s_movk_i32 s90, 0x7fff
    s_cmp_ge_u32 s2, 192
    s_cbranch_scc1 K3_END
    s_load_dwordx2 s[6:7], s[0:1], 120
    s_load_dwordx2 s[8:9], s[0:1], 88
    s_load_dwordx2 s[10:11], s[0:1], 48
    s_load_dwordx2 s[18:19], s[0:1], 104
    s_and_b32 s15, s2, 7
    s_lshr_b32 s3, s2, 3
    s_mov_b32 s14, 357913942
    s_mul_hi_u32 s12, s3, s14
    s_mul_i32 s14, s12, 12
    s_sub_u32 s13, s3, s14
    s_lshl_b32 s12, s12, 3
    s_add_u32 s12, s12, s15
    s_lshl_b32 s12, s12, 7
    s_mul_i32 s13, s13, 48
    v_and_b32 v1, 63, v0
    v_lshrrev_b32 v4, 6, v0
    v_lshrrev_b32 v2, 4, v1
    v_and_b32 v3, 15, v1
    s_movk_i32 s91, 1152
    v_readfirstlane_b32 s89, v4
    v_lshl_add_u32 v5, v4, 5, v3
    v_add_u32 v5, s12, v5
    v_mul_lo_u32 v5, v5, s91
    v_lshl_add_u32 v5, v2, 4, v5
    v_add_u32 v7, 18432, v5
    s_mov_b32 s86, 55296
    s_waitcnt lgkmcnt(0)
    s_add_u32 s16, s6, 2359296
    s_addc_u32 s17, s7, 0
    s_add_u32 s20, s6, 4882432
    s_addc_u32 s21, s7, 0
    s_add_u32 s22, s6, 9764864
    s_addc_u32 s23, s7, 0
    s_add_u32 s24, s6, 12124160
    s_addc_u32 s25, s7, 0
    s_lshl_b32 s92, s13, 1
    s_lshl_b32 s88, s89, 10
    s_mov_b32 s87, 715827883
    v_add_u32 v9, 0, v0
    v_mul_hi_u32 v10, v9, s87
    v_mul_u32_u24 v11, 6, v10
    v_sub_u32 v11, v9, v11
    v_mul_lo_u32 v6, v10, s91
    v_lshl_add_u32 v6, v11, 4, v6
    v_add_u32 v6, s92, v6
    s_add_u32 m0, s88, 0
    s_nop 0
    global_load_lds_dwordx4 v6, s[8:9]
    v_add_u32 v9, 256, v0
    v_mul_hi_u32 v10, v9, s87
    v_mul_u32_u24 v11, 6, v10
    v_sub_u32 v11, v9, v11
    v_mul_lo_u32 v6, v10, s91
    v_lshl_add_u32 v6, v11, 4, v6
    v_add_u32 v6, s92, v6
    s_add_u32 m0, s88, 4096
    s_nop 0
    global_load_lds_dwordx4 v6, s[8:9]
    v_add_u32 v9, 512, v0
    v_mul_hi_u32 v10, v9, s87
    v_mul_u32_u24 v11, 6, v10
    v_sub_u32 v11, v9, v11
    v_mul_lo_u32 v6, v10, s91
    v_lshl_add_u32 v6, v11, 4, v6
    v_add_u32 v6, s92, v6
    s_add_u32 m0, s88, 8192
    s_nop 0
    global_load_lds_dwordx4 v6, s[8:9]
    v_add_u32 v9, 768, v0
    v_mul_hi_u32 v10, v9, s87
    v_mul_u32_u24 v11, 6, v10
    v_sub_u32 v11, v9, v11
    v_mul_lo_u32 v6, v10, s91
    v_lshl_add_u32 v6, v11, 4, v6
    v_add_u32 v6, s92, v6
    s_add_u32 m0, s88, 12288
    s_nop 0
    global_load_lds_dwordx4 v6, s[8:9]
    v_add_u32 v9, 1024, v0
    v_mul_hi_u32 v10, v9, s87
    v_mul_u32_u24 v11, 6, v10
    v_sub_u32 v11, v9, v11
    v_mul_lo_u32 v6, v10, s91
    v_lshl_add_u32 v6, v11, 4, v6
    v_add_u32 v6, s92, v6
    s_add_u32 m0, s88, 16384
    s_nop 0
    global_load_lds_dwordx4 v6, s[8:9]
    v_add_u32 v9, 1280, v0
    v_mul_hi_u32 v10, v9, s87
    v_mul_u32_u24 v11, 6, v10
    v_sub_u32 v11, v9, v11
    v_mul_lo_u32 v6, v10, s91
    v_lshl_add_u32 v6, v11, 4, v6
    v_add_u32 v6, s92, v6
    s_add_u32 m0, s88, 20480
    s_nop 0
    global_load_lds_dwordx4 v6, s[8:9]
    v_add_u32 v9, 1536, v0
    v_mul_hi_u32 v10, v9, s87
    v_mul_u32_u24 v11, 6, v10
    v_sub_u32 v11, v9, v11
    v_mul_lo_u32 v6, v10, s91
    v_lshl_add_u32 v6, v11, 4, v6
    v_add_u32 v6, s92, v6
    s_add_u32 m0, s88, 24576
    s_nop 0
    global_load_lds_dwordx4 v6, s[8:9]
    v_add_u32 v9, 1792, v0
    v_mul_hi_u32 v10, v9, s87
    v_mul_u32_u24 v11, 6, v10
    v_sub_u32 v11, v9, v11
    v_mul_lo_u32 v6, v10, s91
    v_lshl_add_u32 v6, v11, 4, v6
    v_add_u32 v6, s92, v6
    s_add_u32 m0, s88, 28672
    s_nop 0
    global_load_lds_dwordx4 v6, s[8:9]
    v_add_u32 v9, 2048, v0
    v_mul_hi_u32 v10, v9, s87
    v_mul_u32_u24 v11, 6, v10
    v_sub_u32 v11, v9, v11
    v_mul_lo_u32 v6, v10, s91
    v_lshl_add_u32 v6, v11, 4, v6
    v_add_u32 v6, s92, v6
    s_add_u32 m0, s88, 32768
    s_nop 0
    global_load_lds_dwordx4 v6, s[8:9]
    v_add_u32 v9, 2304, v0
    v_mul_hi_u32 v10, v9, s87
    v_mul_u32_u24 v11, 6, v10
    v_sub_u32 v11, v9, v11
    v_mul_lo_u32 v6, v10, s91
    v_lshl_add_u32 v6, v11, 4, v6
    v_add_u32 v6, s92, v6
    s_add_u32 m0, s88, 36864
    s_nop 0
    global_load_lds_dwordx4 v6, s[8:9]
    v_add_u32 v9, 2560, v0
    v_mul_hi_u32 v10, v9, s87
    v_mul_u32_u24 v11, 6, v10
    v_sub_u32 v11, v9, v11
    v_mul_lo_u32 v6, v10, s91
    v_lshl_add_u32 v6, v11, 4, v6
    v_add_u32 v6, s92, v6
    s_add_u32 m0, s88, 40960
    s_nop 0
    global_load_lds_dwordx4 v6, s[8:9]
    v_add_u32 v9, 2816, v0
    v_mul_hi_u32 v10, v9, s87
    v_mul_u32_u24 v11, 6, v10
    v_sub_u32 v11, v9, v11
    v_mul_lo_u32 v6, v10, s91
    v_lshl_add_u32 v6, v11, 4, v6
    v_add_u32 v6, s92, v6
    s_add_u32 m0, s88, 45056
    s_nop 0
    global_load_lds_dwordx4 v6, s[8:9]
    v_add_u32 v9, 3072, v0
    v_mul_hi_u32 v10, v9, s87
    v_mul_u32_u24 v11, 6, v10
    v_sub_u32 v11, v9, v11
    v_mul_lo_u32 v6, v10, s91
    v_lshl_add_u32 v6, v11, 4, v6
    v_add_u32 v6, s92, v6
    s_add_u32 m0, s88, 49152
    s_nop 0
    global_load_lds_dwordx4 v6, s[8:9]
    s_cmp_lt_u32 s89, 2
    s_cbranch_scc0 K3_B13
    v_add_u32 v9, 3328, v0
    v_mul_hi_u32 v10, v9, s87
    v_mul_u32_u24 v11, 6, v10
    v_sub_u32 v11, v9, v11
    v_mul_lo_u32 v6, v10, s91
    v_lshl_add_u32 v6, v11, 4, v6
    v_add_u32 v6, s92, v6
    s_add_u32 m0, s88, 53248
    s_nop 0
    global_load_lds_dwordx4 v6, s[8:9]
K3_B13:
    global_load_dwordx4 v[64:67], v5, s[16:17] offset:0
    global_load_dwordx4 v[68:71], v7, s[16:17] offset:0
    global_load_dwordx4 v[72:75], v5, s[16:17] offset:64
    global_load_dwordx4 v[76:79], v7, s[16:17] offset:64
    global_load_dwordx4 v[80:83], v5, s[16:17] offset:128
    global_load_dwordx4 v[84:87], v7, s[16:17] offset:128
    global_load_dwordx4 v[88:91], v5, s[16:17] offset:192
    global_load_dwordx4 v[92:95], v7, s[16:17] offset:192
    global_load_dwordx4 v[96:99], v5, s[16:17] offset:256
    global_load_dwordx4 v[100:103], v7, s[16:17] offset:256
    global_load_dwordx4 v[104:107], v5, s[16:17] offset:320
    global_load_dwordx4 v[108:111], v7, s[16:17] offset:320
    v_lshlrev_b32 v243, 5, v4
    v_lshl_add_u32 v243, v2, 2, v243
    v_add_u32 v243, s12, v243
    v_add_u32 v13, s13, v3
    v_lshlrev_b32 v14, 12, v13
    v_lshl_add_u32 v14, v243, 1, v14
    v_add_u32 v15, 65536, v14
    v_add_u32 v244, 65536, v15
    v_lshlrev_b32 v13, 1, v13
    v_lshlrev_b32 v245, 2, v243
    v_lshrrev_b32 v10, 2, v3
    v_lshl_add_u32 v10, v2, 3, v10
    v_mul_u32_u24 v8, 96, v10
    v_and_b32 v9, 3, v3
    v_lshl_add_u32 v8, v9, 3, v8
    s_waitcnt vmcnt(12)
    s_barrier
    ds_read_b64_tr_b16 v[16:17], v8 offset:0
    ds_read_b64_tr_b16 v[18:19], v8 offset:384
    ds_read_b64_tr_b16 v[20:21], v8 offset:32
    ds_read_b64_tr_b16 v[22:23], v8 offset:416
    ds_read_b64_tr_b16 v[24:25], v8 offset:64
    ds_read_b64_tr_b16 v[26:27], v8 offset:448
    ds_read_b64_tr_b16 v[28:29], v8 offset:3072
    ds_read_b64_tr_b16 v[30:31], v8 offset:3456
    ds_read_b64_tr_b16 v[32:33], v8 offset:3104
    ds_read_b64_tr_b16 v[34:35], v8 offset:3488
    ds_read_b64_tr_b16 v[36:37], v8 offset:3136
    ds_read_b64_tr_b16 v[38:39], v8 offset:3520
    global_load_dwordx4 v[112:115], v5, s[16:17] offset:384
    global_load_dwordx4 v[116:119], v7, s[16:17] offset:384
    s_waitcnt vmcnt(12) lgkmcnt(6)
    v_mfma_f32_16x16x32_bf16 v[40:43], v[64:67], v[16:19], 0
    v_mfma_f32_16x16x32_bf16 v[44:47], v[64:67], v[20:23], 0
    v_mfma_f32_16x16x32_bf16 v[48:51], v[64:67], v[24:27], 0
    v_mfma_f32_16x16x32_bf16 v[52:55], v[68:71], v[16:19], 0
    v_mfma_f32_16x16x32_bf16 v[56:59], v[68:71], v[20:23], 0
    v_mfma_f32_16x16x32_bf16 v[60:63], v[68:71], v[24:27], 0
    ds_read_b64_tr_b16 v[16:17], v8 offset:6144
    ds_read_b64_tr_b16 v[18:19], v8 offset:6528
    ds_read_b64_tr_b16 v[20:21], v8 offset:6176
    ds_read_b64_tr_b16 v[22:23], v8 offset:6560
    ds_read_b64_tr_b16 v[24:25], v8 offset:6208
    ds_read_b64_tr_b16 v[26:27], v8 offset:6592
    global_load_dwordx4 v[120:123], v5, s[16:17] offset:448
    global_load_dwordx4 v[124:127], v7, s[16:17] offset:448
    s_waitcnt vmcnt(12) lgkmcnt(6)
    v_mfma_f32_16x16x32_bf16 v[40:43], v[72:75], v[28:31], v[40:43]
    v_mfma_f32_16x16x32_bf16 v[44:47], v[72:75], v[32:35], v[44:47]
    v_mfma_f32_16x16x32_bf16 v[48:51], v[72:75], v[36:39], v[48:51]
    v_mfma_f32_16x16x32_bf16 v[52:55], v[76:79], v[28:31], v[52:55]
    v_mfma_f32_16x16x32_bf16 v[56:59], v[76:79], v[32:35], v[56:59]
    v_mfma_f32_16x16x32_bf16 v[60:63], v[76:79], v[36:39], v[60:63]
    ds_read_b64_tr_b16 v[28:29], v8 offset:9216
    ds_read_b64_tr_b16 v[30:31], v8 offset:9600
    ds_read_b64_tr_b16 v[32:33], v8 offset:9248
    ds_read_b64_tr_b16 v[34:35], v8 offset:9632
    ds_read_b64_tr_b16 v[36:37], v8 offset:9280
    ds_read_b64_tr_b16 v[38:39], v8 offset:9664
    global_load_dwordx4 v[128:131], v5, s[16:17] offset:512
    global_load_dwordx4 v[132:135], v7, s[16:17] offset:512
    s_waitcnt vmcnt(12) lgkmcnt(6)
    v_mfma_f32_16x16x32_bf16 v[40:43], v[80:83], v[16:19], v[40:43]
    v_mfma_f32_16x16x32_bf16 v[44:47], v[80:83], v[20:23], v[44:47]
    v_mfma_f32_16x16x32_bf16 v[48:51], v[80:83], v[24:27], v[48:51]
    v_mfma_f32_16x16x32_bf16 v[52:55], v[84:87], v[16:19], v[52:55]
    v_mfma_f32_16x16x32_bf16 v[56:59], v[84:87], v[20:23], v[56:59]
    v_mfma_f32_16x16x32_bf16 v[60:63], v[84:87], v[24:27], v[60:63]
    ds_read_b64_tr_b16 v[16:17], v8 offset:12288
    ds_read_b64_tr_b16 v[18:19], v8 offset:12672
    ds_read_b64_tr_b16 v[20:21], v8 offset:12320
    ds_read_b64_tr_b16 v[22:23], v8 offset:12704
    ds_read_b64_tr_b16 v[24:25], v8 offset:12352
    ds_read_b64_tr_b16 v[26:27], v8 offset:12736
    global_load_dwordx4 v[136:139], v5, s[16:17] offset:576
    global_load_dwordx4 v[140:143], v7, s[16:17] offset:576
    s_waitcnt vmcnt(12) lgkmcnt(6)
    v_mfma_f32_16x16x32_bf16 v[40:43], v[88:91], v[28:31], v[40:43]
    v_mfma_f32_16x16x32_bf16 v[44:47], v[88:91], v[32:35], v[44:47]
    v_mfma_f32_16x16x32_bf16 v[48:51], v[88:91], v[36:39], v[48:51]
    v_mfma_f32_16x16x32_bf16 v[52:55], v[92:95], v[28:31], v[52:55]
    v_mfma_f32_16x16x32_bf16 v[56:59], v[92:95], v[32:35], v[56:59]
    v_mfma_f32_16x16x32_bf16 v[60:63], v[92:95], v[36:39], v[60:63]
    ds_read_b64_tr_b16 v[28:29], v8 offset:15360
    ds_read_b64_tr_b16 v[30:31], v8 offset:15744
    ds_read_b64_tr_b16 v[32:33], v8 offset:15392
    ds_read_b64_tr_b16 v[34:35], v8 offset:15776
    ds_read_b64_tr_b16 v[36:37], v8 offset:15424
    ds_read_b64_tr_b16 v[38:39], v8 offset:15808
    global_load_dwordx4 v[144:147], v5, s[16:17] offset:640
    global_load_dwordx4 v[148:151], v7, s[16:17] offset:640
    s_waitcnt vmcnt(12) lgkmcnt(6)
    v_mfma_f32_16x16x32_bf16 v[40:43], v[96:99], v[16:19], v[40:43]
    v_mfma_f32_16x16x32_bf16 v[44:47], v[96:99], v[20:23], v[44:47]
    v_mfma_f32_16x16x32_bf16 v[48:51], v[96:99], v[24:27], v[48:51]
    v_mfma_f32_16x16x32_bf16 v[52:55], v[100:103], v[16:19], v[52:55]
    v_mfma_f32_16x16x32_bf16 v[56:59], v[100:103], v[20:23], v[56:59]
    v_mfma_f32_16x16x32_bf16 v[60:63], v[100:103], v[24:27], v[60:63]
    ds_read_b64_tr_b16 v[16:17], v8 offset:18432
    ds_read_b64_tr_b16 v[18:19], v8 offset:18816
    ds_read_b64_tr_b16 v[20:21], v8 offset:18464
    ds_read_b64_tr_b16 v[22:23], v8 offset:18848
    ds_read_b64_tr_b16 v[24:25], v8 offset:18496
    ds_read_b64_tr_b16 v[26:27], v8 offset:18880
    global_load_dwordx4 v[152:155], v5, s[16:17] offset:704
    global_load_dwordx4 v[156:159], v7, s[16:17] offset:704
    s_waitcnt vmcnt(12) lgkmcnt(6)
    v_mfma_f32_16x16x32_bf16 v[40:43], v[104:107], v[28:31], v[40:43]
    v_mfma_f32_16x16x32_bf16 v[44:47], v[104:107], v[32:35], v[44:47]
    v_mfma_f32_16x16x32_bf16 v[48:51], v[104:107], v[36:39], v[48:51]
    v_mfma_f32_16x16x32_bf16 v[52:55], v[108:111], v[28:31], v[52:55]
    v_mfma_f32_16x16x32_bf16 v[56:59], v[108:111], v[32:35], v[56:59]
    v_mfma_f32_16x16x32_bf16 v[60:63], v[108:111], v[36:39], v[60:63]
    ds_read_b64_tr_b16 v[28:29], v8 offset:21504
    ds_read_b64_tr_b16 v[30:31], v8 offset:21888
    ds_read_b64_tr_b16 v[32:33], v8 offset:21536
    ds_read_b64_tr_b16 v[34:35], v8 offset:21920
    ds_read_b64_tr_b16 v[36:37], v8 offset:21568
    ds_read_b64_tr_b16 v[38:39], v8 offset:21952
    global_load_dwordx4 v[160:163], v5, s[16:17] offset:768
    global_load_dwordx4 v[164:167], v7, s[16:17] offset:768
    s_waitcnt vmcnt(12) lgkmcnt(6)
    v_mfma_f32_16x16x32_bf16 v[40:43], v[112:115], v[16:19], v[40:43]
    v_mfma_f32_16x16x32_bf16 v[44:47], v[112:115], v[20:23], v[44:47]
    v_mfma_f32_16x16x32_bf16 v[48:51], v[112:115], v[24:27], v[48:51]
    v_mfma_f32_16x16x32_bf16 v[52:55], v[116:119], v[16:19], v[52:55]
    v_mfma_f32_16x16x32_bf16 v[56:59], v[116:119], v[20:23], v[56:59]
    v_mfma_f32_16x16x32_bf16 v[60:63], v[116:119], v[24:27], v[60:63]
    ds_read_b64_tr_b16 v[16:17], v8 offset:24576
    ds_read_b64_tr_b16 v[18:19], v8 offset:24960
    ds_read_b64_tr_b16 v[20:21], v8 offset:24608
    ds_read_b64_tr_b16 v[22:23], v8 offset:24992
    ds_read_b64_tr_b16 v[24:25], v8 offset:24640
    ds_read_b64_tr_b16 v[26:27], v8 offset:25024
    global_load_dwordx4 v[168:171], v5, s[16:17] offset:832
    global_load_dwordx4 v[172:175], v7, s[16:17] offset:832
    s_waitcnt vmcnt(12) lgkmcnt(6)
    v_mfma_f32_16x16x32_bf16 v[40:43], v[120:123], v[28:31], v[40:43]
    v_mfma_f32_16x16x32_bf16 v[44:47], v[120:123], v[32:35], v[44:47]
    v_mfma_f32_16x16x32_bf16 v[48:51], v[120:123], v[36:39], v[48:51]
    v_mfma_f32_16x16x32_bf16 v[52:55], v[124:127], v[28:31], v[52:55]
    v_mfma_f32_16x16x32_bf16 v[56:59], v[124:127], v[32:35], v[56:59]
    v_mfma_f32_16x16x32_bf16 v[60:63], v[124:127], v[36:39], v[60:63]
    ds_read_b64_tr_b16 v[28:29], v8 offset:27648
    ds_read_b64_tr_b16 v[30:31], v8 offset:28032
    ds_read_b64_tr_b16 v[32:33], v8 offset:27680
    ds_read_b64_tr_b16 v[34:35], v8 offset:28064
    ds_read_b64_tr_b16 v[36:37], v8 offset:27712
    ds_read_b64_tr_b16 v[38:39], v8 offset:28096
    global_load_dwordx4 v[176:179], v5, s[16:17] offset:896
    global_load_dwordx4 v[180:183], v7, s[16:17] offset:896
    s_waitcnt vmcnt(12) lgkmcnt(6)
    v_mfma_f32_16x16x32_bf16 v[40:43], v[128:131], v[16:19], v[40:43]
    v_mfma_f32_16x16x32_bf16 v[44:47], v[128:131], v[20:23], v[44:47]
    v_mfma_f32_16x16x32_bf16 v[48:51], v[128:131], v[24:27], v[48:51]
    v_mfma_f32_16x16x32_bf16 v[52:55], v[132:135], v[16:19], v[52:55]
    v_mfma_f32_16x16x32_bf16 v[56:59], v[132:135], v[20:23], v[56:59]
    v_mfma_f32_16x16x32_bf16 v[60:63], v[132:135], v[24:27], v[60:63]
    ds_read_b64_tr_b16 v[16:17], v8 offset:30720
    ds_read_b64_tr_b16 v[18:19], v8 offset:31104
    ds_read_b64_tr_b16 v[20:21], v8 offset:30752
    ds_read_b64_tr_b16 v[22:23], v8 offset:31136
    ds_read_b64_tr_b16 v[24:25], v8 offset:30784
    ds_read_b64_tr_b16 v[26:27], v8 offset:31168
    global_load_dwordx4 v[184:187], v5, s[16:17] offset:960
    global_load_dwordx4 v[188:191], v7, s[16:17] offset:960
    s_waitcnt vmcnt(12) lgkmcnt(6)
    v_mfma_f32_16x16x32_bf16 v[40:43], v[136:139], v[28:31], v[40:43]
    v_mfma_f32_16x16x32_bf16 v[44:47], v[136:139], v[32:35], v[44:47]
    v_mfma_f32_16x16x32_bf16 v[48:51], v[136:139], v[36:39], v[48:51]
    v_mfma_f32_16x16x32_bf16 v[52:55], v[140:143], v[28:31], v[52:55]
    v_mfma_f32_16x16x32_bf16 v[56:59], v[140:143], v[32:35], v[56:59]
    v_mfma_f32_16x16x32_bf16 v[60:63], v[140:143], v[36:39], v[60:63]
    ds_read_b64_tr_b16 v[28:29], v8 offset:33792
    ds_read_b64_tr_b16 v[30:31], v8 offset:34176
    ds_read_b64_tr_b16 v[32:33], v8 offset:33824
    ds_read_b64_tr_b16 v[34:35], v8 offset:34208
    ds_read_b64_tr_b16 v[36:37], v8 offset:33856
    ds_read_b64_tr_b16 v[38:39], v8 offset:34240
    global_load_dwordx4 v[192:195], v5, s[16:17] offset:1024
    global_load_dwordx4 v[196:199], v7, s[16:17] offset:1024
    s_waitcnt vmcnt(12) lgkmcnt(6)
    v_mfma_f32_16x16x32_bf16 v[40:43], v[144:147], v[16:19], v[40:43]
    v_mfma_f32_16x16x32_bf16 v[44:47], v[144:147], v[20:23], v[44:47]
    v_mfma_f32_16x16x32_bf16 v[48:51], v[144:147], v[24:27], v[48:51]
    v_mfma_f32_16x16x32_bf16 v[52:55], v[148:151], v[16:19], v[52:55]
    v_mfma_f32_16x16x32_bf16 v[56:59], v[148:151], v[20:23], v[56:59]
    v_mfma_f32_16x16x32_bf16 v[60:63], v[148:151], v[24:27], v[60:63]
    ds_read_b64_tr_b16 v[16:17], v8 offset:36864
    ds_read_b64_tr_b16 v[18:19], v8 offset:37248
    ds_read_b64_tr_b16 v[20:21], v8 offset:36896
    ds_read_b64_tr_b16 v[22:23], v8 offset:37280
    ds_read_b64_tr_b16 v[24:25], v8 offset:36928
    ds_read_b64_tr_b16 v[26:27], v8 offset:37312
    global_load_dwordx4 v[200:203], v5, s[16:17] offset:1088
    global_load_dwordx4 v[204:207], v7, s[16:17] offset:1088
    s_waitcnt vmcnt(12) lgkmcnt(6)
    v_mfma_f32_16x16x32_bf16 v[40:43], v[152:155], v[28:31], v[40:43]
    v_mfma_f32_16x16x32_bf16 v[44:47], v[152:155], v[32:35], v[44:47]
    v_mfma_f32_16x16x32_bf16 v[48:51], v[152:155], v[36:39], v[48:51]
    v_mfma_f32_16x16x32_bf16 v[52:55], v[156:159], v[28:31], v[52:55]
    v_mfma_f32_16x16x32_bf16 v[56:59], v[156:159], v[32:35], v[56:59]
    v_mfma_f32_16x16x32_bf16 v[60:63], v[156:159], v[36:39], v[60:63]
    ds_read_b64_tr_b16 v[28:29], v8 offset:39936
    ds_read_b64_tr_b16 v[30:31], v8 offset:40320
    ds_read_b64_tr_b16 v[32:33], v8 offset:39968
    ds_read_b64_tr_b16 v[34:35], v8 offset:40352
    ds_read_b64_tr_b16 v[36:37], v8 offset:40000
    ds_read_b64_tr_b16 v[38:39], v8 offset:40384
    global_load_dwordx4 v[208:211], v245, s[20:21] offset:0
    global_load_dwordx4 v[212:215], v245, s[20:21] offset:64
    global_load_ushort v240, v13, s[10:11] offset:0
    s_waitcnt vmcnt(13) lgkmcnt(6)
    v_mfma_f32_16x16x32_bf16 v[40:43], v[160:163], v[16:19], v[40:43]
    v_mfma_f32_16x16x32_bf16 v[44:47], v[160:163], v[20:23], v[44:47]
    v_mfma_f32_16x16x32_bf16 v[48:51], v[160:163], v[24:27], v[48:51]
    v_mfma_f32_16x16x32_bf16 v[52:55], v[164:167], v[16:19], v[52:55]
    v_mfma_f32_16x16x32_bf16 v[56:59], v[164:167], v[20:23], v[56:59]
    v_mfma_f32_16x16x32_bf16 v[60:63], v[164:167], v[24:27], v[60:63]
    ds_read_b64_tr_b16 v[16:17], v8 offset:43008
    ds_read_b64_tr_b16 v[18:19], v8 offset:43392
    ds_read_b64_tr_b16 v[20:21], v8 offset:43040
    ds_read_b64_tr_b16 v[22:23], v8 offset:43424
    ds_read_b64_tr_b16 v[24:25], v8 offset:43072
    ds_read_b64_tr_b16 v[26:27], v8 offset:43456
    global_load_ushort v241, v13, s[10:11] offset:32
    global_load_ushort v242, v13, s[10:11] offset:64
    global_load_dwordx2 v[216:217], v14, s[22:23] offset:0
    s_waitcnt vmcnt(14) lgkmcnt(6)
    v_mfma_f32_16x16x32_bf16 v[40:43], v[168:171], v[28:31], v[40:43]
    v_mfma_f32_16x16x32_bf16 v[44:47], v[168:171], v[32:35], v[44:47]
    v_mfma_f32_16x16x32_bf16 v[48:51], v[168:171], v[36:39], v[48:51]
    v_mfma_f32_16x16x32_bf16 v[52:55], v[172:175], v[28:31], v[52:55]
    v_mfma_f32_16x16x32_bf16 v[56:59], v[172:175], v[32:35], v[56:59]
    v_mfma_f32_16x16x32_bf16 v[60:63], v[172:175], v[36:39], v[60:63]
    ds_read_b64_tr_b16 v[28:29], v8 offset:46080
    ds_read_b64_tr_b16 v[30:31], v8 offset:46464
    ds_read_b64_tr_b16 v[32:33], v8 offset:46112
    ds_read_b64_tr_b16 v[34:35], v8 offset:46496
    ds_read_b64_tr_b16 v[36:37], v8 offset:46144
    ds_read_b64_tr_b16 v[38:39], v8 offset:46528
    global_load_dwordx2 v[228:229], v14, s[24:25] offset:0
    global_load_dwordx2 v[218:219], v14, s[22:23] offset:32
    global_load_dwordx2 v[230:231], v14, s[24:25] offset:32
    s_waitcnt vmcnt(15) lgkmcnt(6)
    v_mfma_f32_16x16x32_bf16 v[40:43], v[176:179], v[16:19], v[40:43]
    v_mfma_f32_16x16x32_bf16 v[44:47], v[176:179], v[20:23], v[44:47]
    v_mfma_f32_16x16x32_bf16 v[48:51], v[176:179], v[24:27], v[48:51]
    v_mfma_f32_16x16x32_bf16 v[52:55], v[180:183], v[16:19], v[52:55]
    v_mfma_f32_16x16x32_bf16 v[56:59], v[180:183], v[20:23], v[56:59]
    v_mfma_f32_16x16x32_bf16 v[60:63], v[180:183], v[24:27], v[60:63]
    ds_read_b64_tr_b16 v[16:17], v8 offset:49152
    ds_read_b64_tr_b16 v[18:19], v8 offset:49536
    ds_read_b64_tr_b16 v[20:21], v8 offset:49184
    ds_read_b64_tr_b16 v[22:23], v8 offset:49568
    ds_read_b64_tr_b16 v[24:25], v8 offset:49216
    ds_read_b64_tr_b16 v[26:27], v8 offset:49600
    global_load_dwordx2 v[220:221], v15, s[22:23] offset:0
    global_load_dwordx2 v[232:233], v15, s[24:25] offset:0
    global_load_dwordx2 v[222:223], v15, s[22:23] offset:32
    s_waitcnt vmcnt(16) lgkmcnt(6)
    v_mfma_f32_16x16x32_bf16 v[40:43], v[184:187], v[28:31], v[40:43]
    v_mfma_f32_16x16x32_bf16 v[44:47], v[184:187], v[32:35], v[44:47]
    v_mfma_f32_16x16x32_bf16 v[48:51], v[184:187], v[36:39], v[48:51]
    v_mfma_f32_16x16x32_bf16 v[52:55], v[188:191], v[28:31], v[52:55]
    v_mfma_f32_16x16x32_bf16 v[56:59], v[188:191], v[32:35], v[56:59]
    v_mfma_f32_16x16x32_bf16 v[60:63], v[188:191], v[36:39], v[60:63]
    ds_read_b64_tr_b16 v[28:29], v8 offset:52224
    ds_read_b64_tr_b16 v[30:31], v8 offset:52608
    ds_read_b64_tr_b16 v[32:33], v8 offset:52256
    ds_read_b64_tr_b16 v[34:35], v8 offset:52640
    ds_read_b64_tr_b16 v[36:37], v8 offset:52288
    ds_read_b64_tr_b16 v[38:39], v8 offset:52672
    global_load_dwordx2 v[234:235], v15, s[24:25] offset:32
    global_load_dwordx2 v[224:225], v244, s[22:23] offset:0
    global_load_dwordx2 v[236:237], v244, s[24:25] offset:0
    s_waitcnt vmcnt(17) lgkmcnt(6)
    v_mfma_f32_16x16x32_bf16 v[40:43], v[192:195], v[16:19], v[40:43]
    v_mfma_f32_16x16x32_bf16 v[44:47], v[192:195], v[20:23], v[44:47]
    v_mfma_f32_16x16x32_bf16 v[48:51], v[192:195], v[24:27], v[48:51]
    v_mfma_f32_16x16x32_bf16 v[52:55], v[196:199], v[16:19], v[52:55]
    v_mfma_f32_16x16x32_bf16 v[56:59], v[196:199], v[20:23], v[56:59]
    v_mfma_f32_16x16x32_bf16 v[60:63], v[196:199], v[24:27], v[60:63]
    global_load_dwordx2 v[226:227], v244, s[22:23] offset:32
    global_load_dwordx2 v[238:239], v244, s[24:25] offset:32
    s_waitcnt vmcnt(17) lgkmcnt(0)
    v_mfma_f32_16x16x32_bf16 v[40:43], v[200:203], v[28:31], v[40:43]
    v_mfma_f32_16x16x32_bf16 v[44:47], v[200:203], v[32:35], v[44:47]
    v_mfma_f32_16x16x32_bf16 v[48:51], v[200:203], v[36:39], v[48:51]
    v_mfma_f32_16x16x32_bf16 v[52:55], v[204:207], v[28:31], v[52:55]
    v_mfma_f32_16x16x32_bf16 v[56:59], v[204:207], v[32:35], v[56:59]
    v_mfma_f32_16x16x32_bf16 v[60:63], v[204:207], v[36:39], v[60:63]
    s_nop 15
    s_waitcnt vmcnt(0)
    v_lshlrev_b32 v240, 16, v240
    v_lshlrev_b32 v241, 16, v241
    v_lshlrev_b32 v242, 16, v242
    v_sub_f32 v72, 1.0, v208
    v_sub_f32 v73, 1.0, v209
    v_sub_f32 v74, 1.0, v210
    v_sub_f32 v75, 1.0, v211
    v_sub_f32 v76, 1.0, v212
    v_sub_f32 v77, 1.0, v213
    v_sub_f32 v78, 1.0, v214
    v_sub_f32 v79, 1.0, v215
    v_lshlrev_b32 v66, 16, v228
    v_lshlrev_b32 v65, 16, v216
    v_fma_f32 v66, v66, v240, v65
    v_mul_f32 v40, v72, v40
    v_fma_f32 v40, v208, v66, v40
    v_and_b32 v66, 0xffff0000, v228
    v_and_b32 v65, 0xffff0000, v216
    v_fma_f32 v66, v66, v240, v65
    v_mul_f32 v41, v73, v41
    v_fma_f32 v41, v209, v66, v41
    v_lshlrev_b32 v66, 16, v229
    v_lshlrev_b32 v65, 16, v217
    v_fma_f32 v66, v66, v240, v65
    v_mul_f32 v42, v74, v42
    v_fma_f32 v42, v210, v66, v42
    v_and_b32 v66, 0xffff0000, v229
    v_and_b32 v65, 0xffff0000, v217
    v_fma_f32 v66, v66, v240, v65
    v_mul_f32 v43, v75, v43
    v_fma_f32 v43, v211, v66, v43
    v_lshlrev_b32 v66, 16, v232
    v_lshlrev_b32 v65, 16, v220
    v_fma_f32 v66, v66, v241, v65
    v_mul_f32 v44, v72, v44
    v_fma_f32 v44, v208, v66, v44
    v_and_b32 v66, 0xffff0000, v232
    v_and_b32 v65, 0xffff0000, v220
    v_fma_f32 v66, v66, v241, v65
    v_mul_f32 v45, v73, v45
    v_fma_f32 v45, v209, v66, v45
    v_lshlrev_b32 v66, 16, v233
    v_lshlrev_b32 v65, 16, v221
    v_fma_f32 v66, v66, v241, v65
    v_mul_f32 v46, v74, v46
    v_fma_f32 v46, v210, v66, v46
    v_and_b32 v66, 0xffff0000, v233
    v_and_b32 v65, 0xffff0000, v221
    v_fma_f32 v66, v66, v241, v65
    v_mul_f32 v47, v75, v47
    v_fma_f32 v47, v211, v66, v47
    v_lshlrev_b32 v66, 16, v236
    v_lshlrev_b32 v65, 16, v224
    v_fma_f32 v66, v66, v242, v65
    v_mul_f32 v48, v72, v48
    v_fma_f32 v48, v208, v66, v48
    v_and_b32 v66, 0xffff0000, v236
    v_and_b32 v65, 0xffff0000, v224
    v_fma_f32 v66, v66, v242, v65
    v_mul_f32 v49, v73, v49
    v_fma_f32 v49, v209, v66, v49
    v_lshlrev_b32 v66, 16, v237
    v_lshlrev_b32 v65, 16, v225
    v_fma_f32 v66, v66, v242, v65
    v_mul_f32 v50, v74, v50
    v_fma_f32 v50, v210, v66, v50
    v_and_b32 v66, 0xffff0000, v237
    v_and_b32 v65, 0xffff0000, v225
    v_fma_f32 v66, v66, v242, v65
    v_mul_f32 v51, v75, v51
    v_fma_f32 v51, v211, v66, v51
    v_lshlrev_b32 v66, 16, v230
    v_lshlrev_b32 v65, 16, v218
    v_fma_f32 v66, v66, v240, v65
    v_mul_f32 v52, v76, v52
    v_fma_f32 v52, v212, v66, v52
    v_and_b32 v66, 0xffff0000, v230
    v_and_b32 v65, 0xffff0000, v218
    v_fma_f32 v66, v66, v240, v65
    v_mul_f32 v53, v77, v53
    v_fma_f32 v53, v213, v66, v53
    v_lshlrev_b32 v66, 16, v231
    v_lshlrev_b32 v65, 16, v219
    v_fma_f32 v66, v66, v240, v65
    v_mul_f32 v54, v78, v54
    v_fma_f32 v54, v214, v66, v54
    v_and_b32 v66, 0xffff0000, v231
    v_and_b32 v65, 0xffff0000, v219
    v_fma_f32 v66, v66, v240, v65
    v_mul_f32 v55, v79, v55
    v_fma_f32 v55, v215, v66, v55
    v_lshlrev_b32 v66, 16, v234
    v_lshlrev_b32 v65, 16, v222
    v_fma_f32 v66, v66, v241, v65
    v_mul_f32 v56, v76, v56
    v_fma_f32 v56, v212, v66, v56
    v_and_b32 v66, 0xffff0000, v234
    v_and_b32 v65, 0xffff0000, v222
    v_fma_f32 v66, v66, v241, v65
    v_mul_f32 v57, v77, v57
    v_fma_f32 v57, v213, v66, v57
    v_lshlrev_b32 v66, 16, v235
    v_lshlrev_b32 v65, 16, v223
    v_fma_f32 v66, v66, v241, v65
    v_mul_f32 v58, v78, v58
    v_fma_f32 v58, v214, v66, v58
    v_and_b32 v66, 0xffff0000, v235
    v_and_b32 v65, 0xffff0000, v223
    v_fma_f32 v66, v66, v241, v65
    v_mul_f32 v59, v79, v59
    v_fma_f32 v59, v215, v66, v59
    v_lshlrev_b32 v66, 16, v238
    v_lshlrev_b32 v65, 16, v226
    v_fma_f32 v66, v66, v242, v65
    v_mul_f32 v60, v76, v60
    v_fma_f32 v60, v212, v66, v60
    v_and_b32 v66, 0xffff0000, v238
    v_and_b32 v65, 0xffff0000, v226
    v_fma_f32 v66, v66, v242, v65
    v_mul_f32 v61, v77, v61
    v_fma_f32 v61, v213, v66, v61
    v_lshlrev_b32 v66, 16, v239
    v_lshlrev_b32 v65, 16, v227
    v_fma_f32 v66, v66, v242, v65
    v_mul_f32 v62, v78, v62
    v_fma_f32 v62, v214, v66, v62
    v_and_b32 v66, 0xffff0000, v239
    v_and_b32 v65, 0xffff0000, v227
    v_fma_f32 v66, v66, v242, v65
    v_mul_f32 v63, v79, v63
    v_fma_f32 v63, v215, v66, v63
    v_mul_u32_u24 v9, 3072, v4
    v_mul_u32_u24 v10, 384, v2
    v_add3_u32 v9, v9, v10, s86
    v_lshl_add_u32 v10, v3, 1, v9
    v_cvt_pk_bf16_f32 v40, v40, v41
    v_cvt_pk_bf16_f32 v42, v42, v43
    ds_write_b16 v10, v40 offset:0
    ds_write_b16_d16_hi v10, v40 offset:96
    ds_write_b16 v10, v42 offset:192
    ds_write_b16_d16_hi v10, v42 offset:288
    v_cvt_pk_bf16_f32 v44, v44, v45
    v_cvt_pk_bf16_f32 v46, v46, v47
    ds_write_b16 v10, v44 offset:32
    ds_write_b16_d16_hi v10, v44 offset:128
    ds_write_b16 v10, v46 offset:224
    ds_write_b16_d16_hi v10, v46 offset:320
    v_cvt_pk_bf16_f32 v48, v48, v49
    v_cvt_pk_bf16_f32 v50, v50, v51
    ds_write_b16 v10, v48 offset:64
    ds_write_b16_d16_hi v10, v48 offset:160
    ds_write_b16 v10, v50 offset:256
    ds_write_b16_d16_hi v10, v50 offset:352
    v_cvt_pk_bf16_f32 v52, v52, v53
    v_cvt_pk_bf16_f32 v54, v54, v55
    ds_write_b16 v10, v52 offset:1536
    ds_write_b16_d16_hi v10, v52 offset:1632
    ds_write_b16 v10, v54 offset:1728
    ds_write_b16_d16_hi v10, v54 offset:1824
    v_cvt_pk_bf16_f32 v56, v56, v57
    v_cvt_pk_bf16_f32 v58, v58, v59
    ds_write_b16 v10, v56 offset:1568
    ds_write_b16_d16_hi v10, v56 offset:1664
    ds_write_b16 v10, v58 offset:1760
    ds_write_b16_d16_hi v10, v58 offset:1856
    v_cvt_pk_bf16_f32 v60, v60, v61
    v_cvt_pk_bf16_f32 v62, v62, v63
    ds_write_b16 v10, v60 offset:1600
    ds_write_b16_d16_hi v10, v60 offset:1696
    ds_write_b16 v10, v62 offset:1792
    ds_write_b16_d16_hi v10, v62 offset:1888
    s_mov_b32 s87, 715827883
    v_mul_u32_u24 v9, 3072, v4
    v_add_u32 v9, s86, v9
    v_lshl_add_u32 v9, v1, 4, v9
    s_waitcnt lgkmcnt(0)
    ds_read_b128 v[64:67], v9 offset:0
    ds_read_b128 v[68:71], v9 offset:1024
    ds_read_b128 v[72:75], v9 offset:2048
    v_lshlrev_b32 v12, 5, v4
    v_add_u32 v12, s12, v12
    s_lshl_b32 s92, s13, 1
    v_add_u32 v9, 0, v1
    v_mul_hi_u32 v10, v9, s87
    v_mul_u32_u24 v11, 6, v10
    v_sub_u32 v11, v9, v11
    v_add_u32 v10, v12, v10
    v_mul_lo_u32 v10, v10, s91
    v_lshl_add_u32 v10, v11, 4, v10
    v_add_u32 v10, s92, v10
    s_waitcnt lgkmcnt(2)
    global_store_dwordx4 v10, v[64:67], s[18:19]
    v_add_u32 v9, 64, v1
    v_mul_hi_u32 v10, v9, s87
    v_mul_u32_u24 v11, 6, v10
    v_sub_u32 v11, v9, v11
    v_add_u32 v10, v12, v10
    v_mul_lo_u32 v10, v10, s91
    v_lshl_add_u32 v10, v11, 4, v10
    v_add_u32 v10, s92, v10
    s_waitcnt lgkmcnt(1)
    global_store_dwordx4 v10, v[68:71], s[18:19]
    v_add_u32 v9, 128, v1
    v_mul_hi_u32 v10, v9, s87
    v_mul_u32_u24 v11, 6, v10
    v_sub_u32 v11, v9, v11
    v_add_u32 v10, v12, v10
    v_mul_lo_u32 v10, v10, s91
    v_lshl_add_u32 v10, v11, 4, v10
    v_add_u32 v10, s92, v10
    s_waitcnt lgkmcnt(0)
    global_store_dwordx4 v10, v[72:75], s[18:19]
K3_END:
    s_endpgm
.section .rodata,"a"
.p2align 6
.amdhsa_kernel prep_kernel
  .amdhsa_next_free_vgpr 224
  .amdhsa_next_free_sgpr 96
  .amdhsa_accum_offset 224
  .amdhsa_group_segment_fixed_size 0
  .amdhsa_kernarg_size 128
  .amdhsa_user_sgpr_count 2
  .amdhsa_user_sgpr_kernarg_segment_ptr 1
  .amdhsa_system_sgpr_workgroup_id_x 1
.end_amdhsa_kernel
.section .rodata,"a"
.p2align 6
.amdhsa_kernel attn_kernel
  .amdhsa_next_free_vgpr 160
  .amdhsa_next_free_sgpr 96
  .amdhsa_accum_offset 160
  .amdhsa_group_segment_fixed_size 0
  .amdhsa_kernarg_size 128
  .amdhsa_user_sgpr_count 2
  .amdhsa_user_sgpr_kernarg_segment_ptr 1
  .amdhsa_system_sgpr_workgroup_id_x 1
.end_amdhsa_kernel
.section .rodata,"a"
.p2align 6
.amdhsa_kernel outp_kernel
  .amdhsa_next_free_vgpr 248
  .amdhsa_next_free_sgpr 96
  .amdhsa_accum_offset 248
  .amdhsa_group_segment_fixed_size 0
  .amdhsa_kernarg_size 128
  .amdhsa_user_sgpr_count 2
  .amdhsa_user_sgpr_kernarg_segment_ptr 1
  .amdhsa_system_sgpr_workgroup_id_x 1
.end_amdhsa_kernel
```
